```python
import torch

def _softmax(x, axis=-1):
    return torch.softmax(x, dim=axis)
def _gelu(x):
    return torch.nn.functional.gelu(x, approximate="tanh")
def _silu(x):
    return torch.nn.functional.silu(x)
def _sigmoid(x):
    return torch.sigmoid(x)
def _layernorm(x, axis=-1, eps=1e-5):
    m = x.mean(dim=axis, keepdim=True)
    v = x.var(dim=axis, keepdim=True, unbiased=False)
    return (x - m) / torch.sqrt(v + eps)
def _scatter_add(tgt, idx, src, axis=0):
    return tgt.clone().index_add_(axis, idx, src)
def _segment_sum(src, seg, n):
    out = torch.zeros((n,) + src.shape[1:], dtype=src.dtype)
    return out.index_add_(0, seg, src)
def _pad(x, pw):
    flat = tuple(v for pair in reversed(pw) for v in pair)
    return torch.nn.functional.pad(x, flat)

kernel_name = 'sequential_preLN__ssm_conv_s4__moe_arch_mod__prompt'

def setup_inputs():

    _w = (lambda a: (lambda t: t.to(torch.bfloat16) if t.is_floating_point() else t)(torch.as_tensor(a)))
    def _A_setup():
        B, L, D, N = 1, 2048, 448, 256
        A_re = -(lambda _x: torch.exp(torch.as_tensor(_x)))((lambda *s: torch.randn(*s, dtype=torch.bfloat16) * 6.4)(D, N))
        A_im = torch.pi * (lambda *s: torch.randn(*s, dtype=torch.bfloat16) * 0.05)(D, N)
        B_re = (lambda *s: torch.randn(*s, dtype=torch.bfloat16) * 0.05)(D, N)
        B_im = (lambda *s: torch.randn(*s, dtype=torch.bfloat16) * 0.05)(D, N)
        C_re = (lambda *s: torch.randn(*s, dtype=torch.bfloat16) * 0.05)(D, N)
        C_im = (lambda *s: torch.randn(*s, dtype=torch.bfloat16) * 0.05)(D, N)
        log_dt = (lambda *s: torch.randn(*s, dtype=torch.bfloat16) * 0.05)(D) * 0.5 - 4.0
        Dskip = (lambda *s: torch.randn(*s, dtype=torch.bfloat16) * 0.05)(D)
        return {
            "u": _w((lambda *s: torch.randn(*s, dtype=torch.bfloat16) * 0.05)(B, L, D)),
            "A_re": _w(A_re),
            "A_im": _w(A_im),
            "B_re": _w(B_re),
            "B_im": _w(B_im),
            "C_re": _w(C_re),
            "C_im": _w(C_im),
            "log_dt": _w(log_dt),
            "Dskip": _w(Dskip),
        }
    _A_in = _A_setup()

    def _B_setup():
        B, S, D, F, C = 1, 2048, 448, 1792, 1
        return {
            "x": _w((lambda *s: torch.randn(*s, dtype=torch.bfloat16) * 0.05)(B, S, D)),
            "w_r": _w((lambda *s: torch.randn(*s, dtype=torch.bfloat16) * 0.05)(D)),
            "w_gate": _w((lambda *s: torch.randn(*s, dtype=torch.bfloat16) * 0.05)(D, F)),
            "w_up": _w((lambda *s: torch.randn(*s, dtype=torch.bfloat16) * 0.05)(D, F)),
            "w_down": _w((lambda *s: torch.randn(*s, dtype=torch.bfloat16) * 0.05)(F, D)),
        }
    _B_in = _B_setup()

    return {
        "A_u": _A_in["u"],
        "A_A_re": _A_in["A_re"],
        "A_A_im": _A_in["A_im"],
        "A_B_re": _A_in["B_re"],
        "A_B_im": _A_in["B_im"],
        "A_C_re": _A_in["C_re"],
        "A_C_im": _A_in["C_im"],
        "A_log_dt": _A_in["log_dt"],
        "A_Dskip": _A_in["Dskip"],
        "B_x": _B_in["x"],
        "B_w_r": _B_in["w_r"],
        "B_w_gate": _B_in["w_gate"],
        "B_w_up": _B_in["w_up"],
        "B_w_down": _B_in["w_down"],
    }

def reference(A_u, A_A_re, A_A_im, A_B_re, A_B_im, A_C_re, A_C_im, A_log_dt, A_Dskip, B_x, B_w_r, B_w_gate, B_w_up, B_w_down):
    def _A_ref(u, A_re, A_im, B_re, B_im, C_re, C_im, log_dt, Dskip):
        Bsz, L, D = u.shape
        dt = torch.exp(log_dt)[:, None]
        A = A_re + 1j * A_im
        Bc = B_re + 1j * B_im
        Cc = C_re + 1j * C_im
        logdA = dt * A
        dB = dt * Bc
        l = (lambda x, dt: x.to(dt))(torch.arange(L), A_re.dtype)
        P = torch.exp(logdA[:, :, None] * l[None, None, :])
        K = torch.einsum("dn,dnl,dn->dl", Cc, P, dB).real
        L2 = 2 * L
        Kp = _pad(K, ((0, 0), (0, L)))
        up = (lambda x, *d: x.permute(*d))(u, 0, 2, 1)
        up = _pad(up, ((0, 0), (0, 0), (0, L)))
        Kf = (lambda x, axes=(-2,-1): torch.fft.rfft2(x.float(), dim=axes))(Kp[:, None, :], axes=(-2, -1))
        Uf = (lambda x, axes=(-2,-1): torch.fft.rfft2(x.float(), dim=axes))(up[:, :, None, :], axes=(-2, -1))
        Yf = Uf * Kf[None, :, :, :]
        y = (lambda x, s, axes=(-2,-1): torch.fft.irfft2(x, s=s, dim=axes).to(torch.bfloat16))(Yf, (1, L2), axes=(-2, -1))[:, :, 0, :L]
        y = (lambda x, *d: x.permute(*d))(y, 0, 2, 1) + u * Dskip[None, None, :]
        return y

    def _B_ref(x, w_r, w_gate, w_up, w_down):
        B, S, D = x.shape
        C = 1
        r = x @ w_r
        idx = torch.argsort(-r, axis=-1)[:, :C]
        idx_e = (lambda x, n, axis: torch.repeat_interleave(x, n, dim=axis))(idx.reshape(B, C, 1), D, axis=2)
        x_sel = (lambda x, i, axis: torch.take_along_dim(x, i, dim=axis))(x, idx_e, axis=1)
        g = _silu(x_sel @ w_gate)
        u = x_sel @ w_up
        y = (g * u) @ w_down
        r_sel = _sigmoid((lambda x, i, axis: torch.take_along_dim(x, i, dim=axis))(r, idx, axis=1))
        y = y * r_sel.reshape(B, C, 1)
        b_off = (torch.arange(B) * S).reshape(B, 1)
        flat_idx = (idx + b_off).reshape(B * C)
        zero = (x * 0.0).reshape(B * S, D)
        upd = _scatter_add(zero, flat_idx, y.reshape(B * C, D), axis=0)
        return x + upd.reshape(B, S, D)

    x = A_u
    h = x + _A_ref(_layernorm(x, axis=-1), A_A_re, A_A_im, A_B_re, A_B_im, A_C_re, A_C_im, A_log_dt, A_Dskip)
    h2 = h + _B_ref(_layernorm(h, axis=-1), B_w_r, B_w_gate, B_w_up, B_w_down)
    return h2
```

```asm
; @launch grid=(256,1,1) block=(512,1,1) lds=145536
.amdgcn_target "amdgcn-amd-amdhsa--gfx950"
.text
.globl sequential_preLN__ssm_conv_s4__moe_arch_mod__prompt_kernel
.p2align 8
.type sequential_preLN__ssm_conv_s4__moe_arch_mod__prompt_kernel,@function
sequential_preLN__ssm_conv_s4__moe_arch_mod__prompt_kernel:
    s_load_dwordx16 s[4:19], s[0:1], 0
    s_load_dwordx2 s[36:37], s[0:1], 128
    s_load_dwordx16 s[20:35], s[0:1], 64
    s_getpc_b64 s[44:45]
L_pc:
    s_cmp_ge_u32 s2, 256
    s_cbranch_scc1 L_end
    v_readfirstlane_b32 s42, v0
    s_lshr_b32 s39, s2, 3
    s_and_b32 s38, s2, 7
    v_and_b32 v1, 63, v0
    s_lshr_b32 s42, s42, 6
    s_cbranch_scc1 L_nopf
    s_and_b32 s55, s39, 7
    s_lshl_b32 s55, s55, 12
    v_lshl_add_u32 v21, v0, 7, s55
    v_min_u32 v21, L_table+8188-L_pc, v21
    s_mov_b32 exec_hi, 0
    global_load_dword v255, v21, s[44:45]
    s_mov_b32 exec_hi, -1
L_nopf:
    s_cmp_lt_u32 s39, 28
    s_cselect_b32 s55, 28, 4
    s_cselect_b32 s56, 0, 28
    s_cselect_b32 s40, 32, 0
    s_mul_i32 s41, s38, s55
    v_mov_b32 v11, 0
    s_add_u32 s41, s41, s39
    v_lshlrev_b32 v18, 4, v1
    s_sub_u32 s41, s41, s56
    v_mov_b32 v16, 1
    s_and_b32 s50, s42, 3
    s_lshl_b32 s58, s41, 2
    s_add_u32 s55, s58, s50
    s_lshl_b32 s55, s55, 8
    v_lshl_add_u32 v12, v1, 1, s55
    s_mul_i32 s57, s50, 14416
    v_mov_b32 v22, 0x3f80
    v_mov_b32 v56, 0x3fb8aa3b
    s_mov_b32 s92, 0x3fb8aa3b
    s_mov_b32 s93, 0x3e22f983
    s_lshl_b32 s56, s50, 11
    s_add_u32 s56, s56, L_table-L_pc
    v_add_u32 v14, s56, v18
    s_cmp_lt_u32 s42, 4
    s_cbranch_scc0 L_I
    v_mov_b32 v8, 0
    v_mov_b32 v9, 0
    v_mov_b32 v10, 0
    s_mul_i32 s55, s42, 4288
    s_add_u32 s55, s55, 125248
    s_cmp_eq_u32 s42, 0
    s_cselect_b32 s55, 0, s55
    v_add_u32 v24, s55, v18
    s_add_u32 m0, s57, 14208
    s_mov_b64 exec, 0xffffff
    ds_write_b128 v24, v[8:11]
    s_mov_b64 exec, -1
    ds_write_addtid_b32 v22 offset:2448
    v_add_u32 v24, 4, v1
    v_and_b32 v25, 7, v24
    v_bfe_u32 v24, v24, 3, 1
    v_lshlrev_b32 v25, 1, v25
    v_sub_u32 v24, v25, v24
    v_add_u32 v24, 1, v24
    v_mul_u32_u24 v62, 272, v24
    v_lshrrev_b32 v25, 4, v1
    v_lshl_add_u32 v62, v25, 5, v62
    v_add_u32 v62, m0, v62
    v_add_u32_e64 v23, m0, v18
    s_waitcnt lgkmcnt(0)
    global_load_short_d16_hi v216, v12, s[6:7]
    global_load_short_d16_hi v217, v12, s[8:9]
    global_load_short_d16_hi v218, v12, s[10:11]
    global_load_short_d16_hi v219, v12, s[12:13]
    global_load_short_d16_hi v220, v12, s[14:15]
    global_load_short_d16_hi v221, v12, s[16:17]
    s_load_dword s53, s[18:19], s58
    s_barrier
    s_cmp_ge_u32 s39, 28
    s_cbranch_scc1 L_C_spare
    s_lshr_b32 s56, s42, 1
    s_and_b32 s57, s42, 1
    s_mul_i32 s55, s56, 6400
    s_lshl_b32 s58, s57, 2
    s_add_u32 s55, s55, s58
    v_and_b32 v26, 15, v1
    v_lshl_add_u32 v24, v26, 3, s55
    v_lshl_add_u32 v63, v25, 10, v24
    v_add_u32 v55, 5632, v24
    s_mov_b32 exec_lo, 0xffff0000
    s_mov_b32 exec_hi, 0
    v_add_u32 v55, 4096, v24
    s_mov_b32 exec_lo, 0
    s_mov_b32 exec_hi, 0xffff0000
    v_add_u32 v55, 4864, v24
    s_mov_b64 exec, -1
    s_lshl_b32 s55, s56, 2
    v_mov_b32 v20, s55
    s_lshl_b32 s55, s42, 2
    v_mov_b32 v21, s55
    v_bfe_u32 v24, v1, 2, 2
    v_mul_u32_u24 v13, 288, v24
    v_and_b32 v24, 3, v1
    v_lshl_add_u32 v13, v24, 6, v13
    v_and_b32 v25, 0x30, v1
    v_add3_u32 v13, v13, v25, m0
    s_mul_i32 s58, s56, 4288
    s_lshl_b32 s57, s57, 6
    s_add_u32 s58, s58, s57
    s_add_u32 s58, s58, 129544
    v_lshlrev_b32 v17, 3, v26
    v_add3_u32 v17, v17, v25, s58
    v_add_u32 v15, 57664, v23
    s_branch L_C
L_I:
    v_add_u32 v12, 128, v12
    s_add_u32 s40, s40, s41
    s_add_u32 m0, s57, 21184
    v_bfe_u32 v20, v0, 5, 3
    s_lshl_b32 s55, s40, 3
    v_add_u32 v23, s55, v20
    ds_write_addtid_b32 v22 offset:53136
    v_sub_u32 v178, 2047, v23
    v_mul_u32_u24 v23, 896, v23
    v_and_b32 v179, 0x1f0, v18
    v_add_u32 v10, v179, v23
    s_mov_b32 s46, -1
    s_mov_b32 s47, 0xffffff
    s_mov_b32 s48, 0xfffffff
    s_mov_b32 s49, 0xfffffff
    v_mul_u32_u24 v166, 912, v20
    s_mov_b32 s56, 138112
    v_add3_u32 v166, v166, v179, s56
    v_bfe_u32 v24, v1, 2, 2
    v_mul_u32_u24 v167, 912, v24
    v_lshrrev_b32 v24, 4, v1
    v_lshl_add_u32 v167, v24, 5, v167
    v_and_b32 v24, 3, v1
    v_lshlrev_b32 v24, 3, v24
    s_mul_i32 s55, s50, 224
    s_add_u32 s55, s55, 138112
    v_add3_u32 v167, v167, v24, s55
    v_lshrrev_b32 v24, 1, v1
    v_and_b32 v25, 1, v1
    v_mul_u32_u24 v200, 3648, v25
    v_lshlrev_b32 v26, 2, v24
    v_add3_u32 v200, v200, v26, s55
    s_setprio 2
    s_waitcnt lgkmcnt(0)
    global_load_short_d16_hi v216, v12, s[6:7]
    global_load_short_d16_hi v217, v12, s[8:9]
    global_load_short_d16_hi v218, v12, s[10:11]
    global_load_short_d16_hi v219, v12, s[12:13]
    global_load_short_d16_hi v220, v12, s[14:15]
    global_load_short_d16_hi v221, v12, s[16:17]
    s_load_dword s53, s[18:19], s58
    s_barrier
    v_add_u32 v201, 912, v200
    v_add_u32 v202, 1824, v200
    v_add_u32 v203, 2736, v200
    s_mov_b32 s94, 0x3f80
    s_mov_b32 s95, 0x3f800000
    s_mul_i32 s55, s40, 896
    s_mul_i32 s57, s50, 458752
    s_add_u32 s55, s55, s57
    s_add_u32 s55, s55, 4194304
    v_add_u32 v15, s55, v18
    v_add_u32 v177, 229376, v15
    s_lshl_b32 s56, s39, 5
    v_lshl_add_u32 v26, v25, 4, s56
    s_mul_i32 s55, s50, 57344
    s_mul_i32 s57, s38, 229376
    s_add_u32 s55, s55, s57
    s_add_u32 s55, s55, 4194304
    v_mul_u32_u24 v170, 896, v24
    v_add3_u32 v170, v170, v26, s55
    v_add_u32 v171, 28672, v170
    s_and_b32 s56, s40, 31
    s_lshl_b32 s56, s56, 5
    v_lshl_add_u32 v26, v25, 4, s56
    s_mul_i32 s55, s50, 64512
    s_lshr_b32 s57, s40, 5
    s_mul_i32 s57, s57, 258048
    s_add_u32 s55, s55, s57
    s_add_u32 s55, s55, 6291456
    v_mul_u32_u24 v173, 1152, v24
    v_add3_u32 v173, v173, v26, s55
    v_add_u32 v174, 32256, v173
    v_mul_u32_u24 v172, 4288, v25
    v_lshlrev_b32 v24, 4, v24
    s_lshl_b32 s55, s50, 10
    s_add_u32 s56, s55, 129664
    v_add3_u32 v172, v172, v24, s56
    s_add_u32 s55, s55, 71872
    v_add_u32 v17, s55, v18
    s_lshl_b32 s55, s50, 2
    v_mov_b32 v168, s55
    s_mov_b64 exec, s[48:49]
    global_load_dwordx4 v[2:5], v10, s[4:5]
    global_load_dwordx4 v[6:9], v10, s[4:5] offset:448
    global_load_short_d16_hi v148, v23, s[4:5]
    s_mov_b64 exec, -1
    v_mov_b32 v100, 0
    v_mov_b32 v101, 0
    s_mul_i32 s55, s50, 258048
    s_mul_i32 s56, s41, 1152
    s_add_u32 s55, s55, s56
    s_add_u32 s55, s55, 6291456
    v_add_u32 v126, s55, v18
    v_add_u32 v127, 1032192, v126
    v_lshlrev_b32 v13, 3, v25
    s_mov_b32 s52, 0x60006000
    s_waitcnt lgkmcnt(0)
    s_load_dword s43, s[36:37], 0
    s_lshl_b32 s55, s53, 16
    s_and_b32 s56, s53, 0xffff0000
    s_cmp_lt_u32 s50, 2
    s_cselect_b32 s55, s55, s56
    v_mul_f32 v56, s55, v56
    v_exp_f32_e64 v56, v56
    s_nop 0
    v_cvt_pk_bf16_f32 v56, v56, v56
    v_and_b32 v56, 0xffff0000, v56
    v_pk_mul_f32 v[60:61], v[56:57], s[92:93] op_sel_hi:[0,1]
    v_mul_f32 v56, 0x32000000, v56
    s_cmp_ge_u32 s39, 28
    s_cbranch_scc1 L_I_ln1
    s_waitcnt vmcnt(3)
    v_pk_mul_f32 v[58:59], v[216:217], v[60:61]
    v_mul_f32 v42, 0x43800000, v58
    v_mul_f32 v43, 0x43800000, v59
    v_fract_f32 v59, v59
    v_fract_f32 v43, v43
    v_exp_f32 v58, v58
    v_cos_f32 v24, v59
    v_sin_f32 v25, v59
    v_exp_f32 v42, v42
    v_cos_f32 v34, v43
    v_sin_f32_e64 v35, v43
    v_pk_mul_f32 v[24:25], v[24:25], v[58:59] op_sel_hi:[1,0]
    v_cvt_pk_bf16_f32 v50, v24, v25
    ds_write_addtid_b32 v50 offset:53680
    v_pk_mul_f32 v[34:35], v[34:35], v[42:43] op_sel_hi:[1,0]
    v_cvt_pk_bf16_f32 v51, v34, v35
    ds_write_addtid_b32 v51 offset:52864
    v_pk_mul_f32 v[26:27], v[24:25], v[24:25] op_sel:[0,0] op_sel_hi:[0,1]
    v_pk_fma_f32 v[26:27], v[24:25], v[24:25], v[26:27] op_sel:[1,1,0] op_sel_hi:[1,0,1] neg_lo:[1,0,0]
    v_cvt_pk_bf16_f32 v52, v26, v27
    ds_write_addtid_b32 v52 offset:54224
    v_pk_mul_f32 v[28:29], v[26:27], v[26:27] op_sel:[0,0] op_sel_hi:[0,1]
    v_pk_fma_f32 v[28:29], v[26:27], v[26:27], v[28:29] op_sel:[1,1,0] op_sel_hi:[1,0,1] neg_lo:[1,0,0]
    v_cvt_pk_bf16_f32 v53, v28, v29
    ds_write_addtid_b32 v53 offset:50688
    v_pk_mul_f32 v[30:31], v[28:29], v[26:27] op_sel:[0,0] op_sel_hi:[0,1]
    v_pk_fma_f32 v[30:31], v[28:29], v[26:27], v[30:31] op_sel:[1,1,0] op_sel_hi:[1,0,1] neg_lo:[1,0,0]
    v_cvt_pk_bf16_f32 v50, v30, v31
    ds_write_addtid_b32 v50 offset:51776
    v_pk_mul_f32 v[42:43], v[26:27], v[24:25] op_sel:[0,0] op_sel_hi:[0,1]
    v_pk_fma_f32 v[42:43], v[26:27], v[24:25], v[42:43] op_sel:[1,1,0] op_sel_hi:[1,0,1] neg_lo:[1,0,0]
    v_cvt_pk_bf16_f32 v51, v42, v43
    ds_write_addtid_b32 v51 offset:54768
    v_pk_mul_f32 v[42:43], v[28:29], v[24:25] op_sel:[0,0] op_sel_hi:[0,1]
    v_pk_fma_f32 v[42:43], v[28:29], v[24:25], v[42:43] op_sel:[1,1,0] op_sel_hi:[1,0,1] neg_lo:[1,0,0]
    v_cvt_pk_bf16_f32 v52, v42, v43
    ds_write_addtid_b32 v52 offset:51232
    v_pk_mul_f32 v[42:43], v[30:31], v[24:25] op_sel:[0,0] op_sel_hi:[0,1]
    v_pk_fma_f32 v[42:43], v[30:31], v[24:25], v[42:43] op_sel:[1,1,0] op_sel_hi:[1,0,1] neg_lo:[1,0,0]
    v_cvt_pk_bf16_f32 v53, v42, v43
    ds_write_addtid_b32 v53 offset:52320
L_I_ln1:
    global_load_dwordx4 v[240:243], v14, s[44:45] offset:1024
    s_waitcnt lgkmcnt(0)
    s_mul_i32 s43, s43, 1664525
    s_add_u32 s43, s43, 1013904223
    v_mov_b32 v19, s43
    v_lshrrev_b32 v13, v13, v19
    v_lshlrev_b32 v196, 13, v13
    v_lshlrev_b32 v197, 11, v13
    v_lshlrev_b32 v198, 9, v13
    v_lshlrev_b32 v199, 7, v13
    v_and_b32 v196, s52, v196
    v_and_b32 v197, s52, v197
    v_and_b32 v198, s52, v198
    v_and_b32_e64 v199, s52, v199
    s_mov_b64 exec, s[48:49]
    s_waitcnt vmcnt(1)
    v_dot2_f32_bf16 v128, v2, s94, v148 neg_lo:[0,0,1]
    v_dot2_f32_bf16 v129, v2, s95, v148 neg_lo:[0,0,1]
    v_dot2_f32_bf16 v130, v3, s94, v148 neg_lo:[0,0,1]
    v_dot2_f32_bf16 v131, v3, s95, v148 neg_lo:[0,0,1]
    v_dot2_f32_bf16 v132, v4, s94, v148 neg_lo:[0,0,1]
    v_dot2_f32_bf16 v133, v4, s95, v148 neg_lo:[0,0,1]
    v_dot2_f32_bf16 v134, v5, s94, v148 neg_lo:[0,0,1]
    v_dot2_f32_bf16 v135, v5, s95, v148 neg_lo:[0,0,1]
    v_dot2_f32_bf16 v136, v6, s94, v148 neg_lo:[0,0,1]
    v_dot2_f32_bf16 v137, v6, s95, v148 neg_lo:[0,0,1]
    v_dot2_f32_bf16 v138, v7, s94, v148 neg_lo:[0,0,1]
    v_dot2_f32_bf16 v139, v7, s95, v148 neg_lo:[0,0,1]
    v_dot2_f32_bf16 v140, v8, s94, v148 neg_lo:[0,0,1]
    v_dot2_f32_bf16 v141, v8, s95, v148 neg_lo:[0,0,1]
    v_dot2_f32_bf16 v142, v9, s94, v148 neg_lo:[0,0,1]
    v_dot2_f32_bf16 v143, v9, s95, v148 neg_lo:[0,0,1]
    v_pk_add_f32 v[96:97], v[128:129], v[130:131]
    v_pk_mul_f32 v[98:99], v[128:129], v[128:129]
    v_pk_fma_f32 v[98:99], v[130:131], v[130:131], v[98:99]
    v_pk_add_f32 v[96:97], v[96:97], v[132:133]
    v_pk_fma_f32 v[98:99], v[132:133], v[132:133], v[98:99]
    v_pk_add_f32 v[96:97], v[96:97], v[134:135]
    v_pk_fma_f32 v[98:99], v[134:135], v[134:135], v[98:99]
    v_pk_add_f32 v[96:97], v[96:97], v[136:137]
    v_pk_fma_f32 v[98:99], v[136:137], v[136:137], v[98:99]
    v_pk_add_f32 v[96:97], v[96:97], v[138:139]
    v_pk_fma_f32 v[98:99], v[138:139], v[138:139], v[98:99]
    v_pk_add_f32 v[96:97], v[96:97], v[140:141]
    v_pk_fma_f32 v[98:99], v[140:141], v[140:141], v[98:99]
    v_pk_add_f32 v[96:97], v[96:97], v[142:143]
    v_pk_fma_f32 v[98:99], v[142:143], v[142:143], v[98:99]
    v_add_f32 v100, v96, v97
    v_add_f32 v101, v98, v99
    s_mov_b64 exec, -1
    v_add_f32_dpp v100, v100, v100 row_ror:8 row_mask:0xf bank_mask:0xf
    v_add_f32_dpp v101, v101, v101 row_ror:8 row_mask:0xf bank_mask:0xf
    s_nop 0
    v_add_f32_dpp v100, v100, v100 row_ror:4 row_mask:0xf bank_mask:0xf
    v_add_f32_dpp v101, v101, v101 row_ror:4 row_mask:0xf bank_mask:0xf
    s_nop 0
    v_add_f32_dpp v100, v100, v100 row_ror:2 row_mask:0xf bank_mask:0xf
    v_add_f32_dpp v101, v101, v101 row_ror:2 row_mask:0xf bank_mask:0xf
    s_nop 0
    v_add_f32_dpp v100, v100, v100 row_ror:1 row_mask:0xf bank_mask:0xf
    v_add_f32_dpp v101, v101, v101 row_ror:1 row_mask:0xf bank_mask:0xf
    v_mov_b32 v96, v100
    v_mov_b32_e64 v97, v101
    s_nop 0
    v_permlane16_swap_b32 v96, v100
    v_permlane16_swap_b32 v97, v101
    v_pk_add_f32 v[96:97], v[96:97], v[100:101]
    v_mul_f32 v144, 0x3b124925, v96
    v_mul_f32 v97, 0x3b124925, v97
    v_fma_f32 v97, -v144, v144, v97
    v_max_f32 v97, 0, v97
    v_add_f32 v97, 0x3727c5ac, v97
    v_rsq_f32 v146, v97
    s_mov_b64 exec, s[48:49]
    v_mul_f32 v98, 0x1d800000, v146
    v_mul_f32 v96, v144, v98
    v_pk_fma_f32 v[64:65], v[128:129], v[98:99], v[96:97] op_sel_hi:[1,0,0] neg_lo:[0,0,1] neg_hi:[0,0,1]
    v_pk_fma_f32 v[66:67], v[130:131], v[98:99], v[96:97] op_sel_hi:[1,0,0] neg_lo:[0,0,1] neg_hi:[0,0,1]
    v_pk_fma_f32 v[68:69], v[132:133], v[98:99], v[96:97] op_sel_hi:[1,0,0] neg_lo:[0,0,1] neg_hi:[0,0,1]
    v_pk_fma_f32 v[70:71], v[134:135], v[98:99], v[96:97] op_sel_hi:[1,0,0] neg_lo:[0,0,1] neg_hi:[0,0,1]
    v_pk_fma_f32 v[72:73], v[136:137], v[98:99], v[96:97] op_sel_hi:[1,0,0] neg_lo:[0,0,1] neg_hi:[0,0,1]
    v_pk_fma_f32 v[74:75], v[138:139], v[98:99], v[96:97] op_sel_hi:[1,0,0] neg_lo:[0,0,1] neg_hi:[0,0,1]
    v_pk_fma_f32 v[76:77], v[140:141], v[98:99], v[96:97] op_sel_hi:[1,0,0] neg_lo:[0,0,1] neg_hi:[0,0,1]
    v_pk_fma_f32 v[78:79], v[142:143], v[98:99], v[96:97] op_sel_hi:[1,0,0] neg_lo:[0,0,1] neg_hi:[0,0,1]
    v_cvt_pk_bf16_f32 v80, v64, v65
    v_cvt_pk_bf16_f32 v81, v66, v67
    v_cvt_pk_bf16_f32 v82, v68, v69
    v_cvt_pk_bf16_f32 v83, v70, v71
    v_cvt_pk_bf16_f32 v84, v72, v73
    v_cvt_pk_bf16_f32 v85, v74, v75
    v_cvt_pk_bf16_f32 v86, v76, v77
    v_cvt_pk_bf16_f32 v87, v78, v79
    ds_write_b128 v166, v[80:83]
    ds_write_b128 v166, v[84:87] offset:448
    s_mov_b64 exec, 1
    ds_add_u32 v11, v16 offset:0
    s_mov_b64 exec, -1
    s_mov_b32 s54, 0
L_sxt:
    ds_read_b32 v64, v11 offset:0
    ds_read_b64_tr_b16 v[88:89], v167
    ds_read_b64_tr_b16 v[90:91], v167 offset:3648
    ds_read_b64_tr_b16 v[92:93], v167 offset:112
    ds_read_b64_tr_b16 v[94:95], v167 offset:3760
    s_add_u32 s54, s54, 1
    s_cmp_gt_u32 s54, 1048576
    s_waitcnt lgkmcnt(0)
    v_cmp_gt_u32 vcc, 4, v64
    s_cbranch_scc1 L_sxt_x
    s_cbranch_vccnz L_sxt
L_sxt_x:
    s_mov_b64 exec, s[46:47]
    s_nop 0
    v_bfi_b32 v88, s52, v196, v88
    v_bfi_b32 v89, s52, v197, v89
    v_bfi_b32 v90, s52, v198, v90
    v_bfi_b32 v91, s52, v199, v91
    v_bfi_b32 v92, s52, v196, v92
    v_bfi_b32 v93, s52, v197, v93
    v_bfi_b32 v94, s52, v198, v94
    v_bfi_b32 v95, s52, v199, v95
    global_store_dwordx4 v15, v[88:91], s[36:37] sc1
    global_store_dwordx4 v177, v[92:95], s[36:37] sc1
    s_mov_b64 exec, -1
    s_cmp_ge_u32 s39, 28
    s_cbranch_scc1 L_I_spare
    s_nop 0
    v_pk_mul_f32 v[42:43], v[34:35], v[26:27] op_sel:[0,0] op_sel_hi:[0,1]
    v_pk_fma_f32 v[42:43], v[34:35], v[26:27], v[42:43] op_sel:[1,1,0] op_sel_hi:[1,0,1] neg_lo:[1,0,0]
    v_cvt_pk_bf16_f32 v50, v42, v43
    ds_write_addtid_b32 v50 offset:53408
    v_pk_mul_f32 v[42:43], v[34:35], v[28:29] op_sel:[0,0] op_sel_hi:[0,1]
    v_pk_fma_f32 v[42:43], v[34:35], v[28:29], v[42:43] op_sel:[1,1,0] op_sel_hi:[1,0,1] neg_lo:[1,0,0]
    v_cvt_pk_bf16_f32 v51, v42, v43
    ds_write_addtid_b32 v51 offset:53952
    v_pk_mul_f32 v[42:43], v[34:35], v[30:31] op_sel:[0,0] op_sel_hi:[0,1]
    v_pk_fma_f32 v[42:43], v[34:35], v[30:31], v[42:43] op_sel:[1,1,0] op_sel_hi:[1,0,1] neg_lo:[1,0,0]
    v_cvt_pk_bf16_f32 v52, v42, v43
    ds_write_addtid_b32 v52 offset:54496
    v_pk_mul_f32 v[36:37], v[34:35], v[34:35] op_sel:[0,0] op_sel_hi:[0,1]
    v_pk_fma_f32 v[36:37], v[34:35], v[34:35], v[36:37] op_sel:[1,1,0] op_sel_hi:[1,0,1] neg_lo:[1,0,0]
    v_cvt_pk_bf16_f32 v53, v36, v37
    ds_write_addtid_b32 v53 offset:50960
    v_pk_mul_f32 v[42:43], v[36:37], v[28:29] op_sel:[0,0] op_sel_hi:[0,1]
    v_pk_fma_f32 v[42:43], v[36:37], v[28:29], v[42:43] op_sel:[1,1,0] op_sel_hi:[1,0,1] neg_lo:[1,0,0]
    v_cvt_pk_bf16_f32 v50, v42, v43
    ds_write_addtid_b32 v50 offset:51504
    v_pk_mul_f32 v[38:39], v[36:37], v[34:35] op_sel:[0,0] op_sel_hi:[0,1]
    v_pk_fma_f32 v[38:39], v[36:37], v[34:35], v[38:39] op_sel:[1,1,0] op_sel_hi:[1,0,1] neg_lo:[1,0,0]
    v_cvt_pk_bf16_f32 v51, v38, v39
    ds_write_addtid_b32 v51 offset:52048
    v_pk_mul_f32 v[42:43], v[38:39], v[28:29] op_sel:[0,0] op_sel_hi:[0,1]
    v_pk_fma_f32 v[42:43], v[38:39], v[28:29], v[42:43] op_sel:[1,1,0] op_sel_hi:[1,0,1] neg_lo:[1,0,0]
    v_cvt_pk_bf16_f32 v52, v42, v43
    ds_write_addtid_b32 v52 offset:52592
    v_pk_mul_f32 v[40:41], v[36:37], v[36:37] op_sel:[0,0] op_sel_hi:[0,1]
    v_pk_fma_f32 v[40:41], v[36:37], v[36:37], v[40:41] op_sel:[1,1,0] op_sel_hi:[1,0,1] neg_lo:[1,0,0]
    v_cvt_pk_bf16_f32 v53, v40, v41
    ds_write_addtid_b32 v53 offset:55040
    v_pk_mul_f32 v[42:43], v[40:41], v[34:35] op_sel:[0,0] op_sel_hi:[0,1]
    v_pk_fma_f32 v[42:43], v[40:41], v[34:35], v[42:43] op_sel:[1,1,0] op_sel_hi:[1,0,1] neg_lo:[1,0,0]
    v_cvt_pk_bf16_f32 v50, v42, v43
    ds_write_addtid_b32 v50 offset:55584
    v_pk_mul_f32 v[42:43], v[40:41], v[36:37] op_sel:[0,0] op_sel_hi:[0,1]
    v_pk_fma_f32 v[42:43], v[40:41], v[36:37], v[42:43] op_sel:[1,1,0] op_sel_hi:[1,0,1] neg_lo:[1,0,0]
    v_cvt_pk_bf16_f32 v51, v42, v43
    ds_write_addtid_b32 v51 offset:56128
    v_pk_mul_f32 v[42:43], v[40:41], v[38:39] op_sel:[0,0] op_sel_hi:[0,1]
    v_pk_fma_f32 v[42:43], v[40:41], v[38:39], v[42:43] op_sel:[1,1,0] op_sel_hi:[1,0,1] neg_lo:[1,0,0]
    v_cvt_pk_bf16_f32 v52, v42, v43
    ds_write_addtid_b32 v52 offset:55312
    v_pk_mul_f32 v[42:43], v[40:41], v[40:41] op_sel:[0,0] op_sel_hi:[0,1]
    v_pk_fma_f32 v[42:43], v[40:41], v[40:41], v[42:43] op_sel:[1,1,0] op_sel_hi:[1,0,1] neg_lo:[1,0,0]
    v_cvt_pk_bf16_f32 v53, v42, v43
    ds_write_addtid_b32 v53 offset:55856
    v_pk_mul_f32 v[46:47], v[218:219], v[220:221] op_sel:[0,0] op_sel_hi:[0,1]
    v_pk_fma_f32 v[46:47], v[218:219], v[220:221], v[46:47] op_sel:[1,1,0] op_sel_hi:[1,0,1] neg_lo:[1,0,0]
    v_pk_mul_f32 v[46:47], v[46:47], v[56:57] op_sel_hi:[1,0]
    v_cvt_pk_bf16_f32 v50, v46, -v47
    ds_write_addtid_b32 v50 offset:58848
    v_pk_mul_f32 v[32:33], v[28:29], v[28:29] op_sel:[0,0] op_sel_hi:[0,1]
    v_pk_fma_f32 v[32:33], v[28:29], v[28:29], v[32:33] op_sel:[1,1,0] op_sel_hi:[1,0,1] neg_lo:[1,0,0]
    v_pk_mul_f32 v[48:49], v[46:47], v[32:33] op_sel:[0,0] op_sel_hi:[0,1]
    v_pk_fma_f32 v[48:49], v[46:47], v[32:33], v[48:49] op_sel:[1,1,0] op_sel_hi:[1,0,1] neg_lo:[1,0,0]
    v_cvt_pk_bf16_f32 v51, v48, -v49
    ds_write_addtid_b32 v51 offset:59392
    v_pk_mul_f32 v[46:47], v[48:49], v[32:33] op_sel:[0,0] op_sel_hi:[0,1]
    v_pk_fma_f32 v[46:47], v[48:49], v[32:33], v[46:47] op_sel:[1,1,0] op_sel_hi:[1,0,1] neg_lo:[1,0,0]
    v_cvt_pk_bf16_f32 v52, v46, -v47
    ds_write_addtid_b32 v52 offset:59936
    v_pk_mul_f32 v[48:49], v[46:47], v[32:33] op_sel:[0,0] op_sel_hi:[0,1]
    v_pk_fma_f32 v[48:49], v[46:47], v[32:33], v[48:49] op_sel:[1,1,0] op_sel_hi:[1,0,1] neg_lo:[1,0,0]
    v_cvt_pk_bf16_f32 v53, v48, -v49
    ds_write_addtid_b32 v53 offset:60480
    v_pk_mul_f32 v[46:47], v[48:49], v[32:33] op_sel:[0,0] op_sel_hi:[0,1]
    v_pk_fma_f32 v[46:47], v[48:49], v[32:33], v[46:47] op_sel:[1,1,0] op_sel_hi:[1,0,1] neg_lo:[1,0,0]
    v_cvt_pk_bf16_f32 v50, v46, -v47
    ds_write_addtid_b32 v50 offset:56400
    v_pk_mul_f32 v[48:49], v[46:47], v[32:33] op_sel:[0,0] op_sel_hi:[0,1]
    v_pk_fma_f32 v[48:49], v[46:47], v[32:33], v[48:49] op_sel:[1,1,0] op_sel_hi:[1,0,1] neg_lo:[1,0,0]
    v_cvt_pk_bf16_f32 v51, v48, -v49
    ds_write_addtid_b32 v51 offset:56944
    v_pk_mul_f32 v[46:47], v[48:49], v[32:33] op_sel:[0,0] op_sel_hi:[0,1]
    v_pk_fma_f32 v[46:47], v[48:49], v[32:33], v[46:47] op_sel:[1,1,0] op_sel_hi:[1,0,1] neg_lo:[1,0,0]
    v_cvt_pk_bf16_f32 v52, v46, -v47
    ds_write_addtid_b32 v52 offset:57488
    v_pk_mul_f32 v[48:49], v[46:47], v[32:33] op_sel:[0,0] op_sel_hi:[0,1]
    v_pk_fma_f32 v[48:49], v[46:47], v[32:33], v[48:49] op_sel:[1,1,0] op_sel_hi:[1,0,1] neg_lo:[1,0,0]
    v_cvt_pk_bf16_f32 v53, v48, -v49
    ds_write_addtid_b32 v53 offset:58032
    v_pk_mul_f32 v[46:47], v[48:49], v[32:33] op_sel:[0,0] op_sel_hi:[0,1]
    v_pk_fma_f32 v[46:47], v[48:49], v[32:33], v[46:47] op_sel:[1,1,0] op_sel_hi:[1,0,1] neg_lo:[1,0,0]
    v_cvt_pk_bf16_f32 v50, v46, -v47
    ds_write_addtid_b32 v50 offset:58576
    v_pk_mul_f32 v[48:49], v[46:47], v[32:33] op_sel:[0,0] op_sel_hi:[0,1]
    v_pk_fma_f32 v[48:49], v[46:47], v[32:33], v[48:49] op_sel:[1,1,0] op_sel_hi:[1,0,1] neg_lo:[1,0,0]
    v_cvt_pk_bf16_f32 v51, v48, -v49
    ds_write_addtid_b32 v51 offset:59120
    v_pk_mul_f32 v[46:47], v[48:49], v[32:33] op_sel:[0,0] op_sel_hi:[0,1]
    v_pk_fma_f32 v[46:47], v[48:49], v[32:33], v[46:47] op_sel:[1,1,0] op_sel_hi:[1,0,1] neg_lo:[1,0,0]
    v_cvt_pk_bf16_f32 v52, v46, -v47
    ds_write_addtid_b32 v52 offset:59664
    v_pk_mul_f32 v[48:49], v[46:47], v[32:33] op_sel:[0,0] op_sel_hi:[0,1]
    v_pk_fma_f32 v[48:49], v[46:47], v[32:33], v[48:49] op_sel:[1,1,0] op_sel_hi:[1,0,1] neg_lo:[1,0,0]
    v_cvt_pk_bf16_f32 v53, v48, -v49
    ds_write_addtid_b32 v53 offset:60208
    v_pk_mul_f32 v[46:47], v[48:49], v[32:33] op_sel:[0,0] op_sel_hi:[0,1]
    v_pk_fma_f32 v[46:47], v[48:49], v[32:33], v[46:47] op_sel:[1,1,0] op_sel_hi:[1,0,1] neg_lo:[1,0,0]
    v_cvt_pk_bf16_f32 v50, v46, -v47
    ds_write_addtid_b32 v50 offset:56672
    v_pk_mul_f32 v[48:49], v[46:47], v[32:33] op_sel:[0,0] op_sel_hi:[0,1]
    v_pk_fma_f32 v[48:49], v[46:47], v[32:33], v[48:49] op_sel:[1,1,0] op_sel_hi:[1,0,1] neg_lo:[1,0,0]
    v_cvt_pk_bf16_f32 v51, v48, -v49
    ds_write_addtid_b32 v51 offset:57216
    v_pk_mul_f32 v[46:47], v[48:49], v[32:33] op_sel:[0,0] op_sel_hi:[0,1]
    v_pk_fma_f32 v[46:47], v[48:49], v[32:33], v[46:47] op_sel:[1,1,0] op_sel_hi:[1,0,1] neg_lo:[1,0,0]
    v_cvt_pk_bf16_f32 v52, v46, -v47
    ds_write_addtid_b32 v52 offset:57760
    v_pk_mul_f32 v[48:49], v[46:47], v[32:33] op_sel:[0,0] op_sel_hi:[0,1]
    v_pk_fma_f32 v[48:49], v[46:47], v[32:33], v[48:49] op_sel:[1,1,0] op_sel_hi:[1,0,1] neg_lo:[1,0,0]
    v_cvt_pk_bf16_f32 v53, v48, -v49
    ds_write_addtid_b32 v53 offset:58304
    s_mov_b64 exec, 1
    ds_add_u32 v168, v16 offset:48
    s_mov_b64 exec, -1
    v_pk_mul_f32 v[46:47], v[48:49], v[32:33] op_sel:[0,0] op_sel_hi:[0,1]
    v_pk_fma_f32 v[46:47], v[48:49], v[32:33], v[46:47] op_sel:[1,1,0] op_sel_hi:[1,0,1] neg_lo:[1,0,0]
    v_cvt_pk_bf16_f32 v50, v46, -v47
    ds_write_addtid_b32 v50 offset:63200
    v_pk_mul_f32 v[48:49], v[46:47], v[32:33] op_sel:[0,0] op_sel_hi:[0,1]
    v_pk_fma_f32 v[48:49], v[46:47], v[32:33], v[48:49] op_sel:[1,1,0] op_sel_hi:[1,0,1] neg_lo:[1,0,0]
    v_cvt_pk_bf16_f32 v51, v48, -v49
    ds_write_addtid_b32 v51 offset:63744
    global_load_dwordx4 v[180:183], v170, s[36:37] sc1
    global_load_dwordx4 v[184:187], v171, s[36:37] sc1
    v_pk_mul_f32 v[46:47], v[48:49], v[32:33] op_sel:[0,0] op_sel_hi:[0,1]
    v_pk_fma_f32 v[46:47], v[48:49], v[32:33], v[46:47] op_sel:[1,1,0] op_sel_hi:[1,0,1] neg_lo:[1,0,0]
    v_cvt_pk_bf16_f32 v52, v46, -v47
    ds_write_addtid_b32 v52 offset:64288
    v_pk_mul_f32 v[48:49], v[46:47], v[32:33] op_sel:[0,0] op_sel_hi:[0,1]
    v_pk_fma_f32 v[48:49], v[46:47], v[32:33], v[48:49] op_sel:[1,1,0] op_sel_hi:[1,0,1] neg_lo:[1,0,0]
    v_cvt_pk_bf16_f32 v53, v48, -v49
    ds_write_addtid_b32 v53 offset:64832
    v_pk_mul_f32 v[46:47], v[48:49], v[32:33] op_sel:[0,0] op_sel_hi:[0,1]
    v_pk_fma_f32 v[46:47], v[48:49], v[32:33], v[46:47] op_sel:[1,1,0] op_sel_hi:[1,0,1] neg_lo:[1,0,0]
    v_cvt_pk_bf16_f32 v50, v46, -v47
    ds_write_addtid_b32 v50 offset:60752
    v_pk_mul_f32 v[48:49], v[46:47], v[32:33] op_sel:[0,0] op_sel_hi:[0,1]
    v_pk_fma_f32 v[48:49], v[46:47], v[32:33], v[48:49] op_sel:[1,1,0] op_sel_hi:[1,0,1] neg_lo:[1,0,0]
    v_cvt_pk_bf16_f32 v51, v48, -v49
    ds_write_addtid_b32 v51 offset:61296
    v_pk_mul_f32 v[46:47], v[48:49], v[32:33] op_sel:[0,0] op_sel_hi:[0,1]
    v_pk_fma_f32 v[46:47], v[48:49], v[32:33], v[46:47] op_sel:[1,1,0] op_sel_hi:[1,0,1] neg_lo:[1,0,0]
    v_cvt_pk_bf16_f32 v52, v46, -v47
    ds_write_addtid_b32 v52 offset:61840
    v_pk_mul_f32 v[48:49], v[46:47], v[32:33] op_sel:[0,0] op_sel_hi:[0,1]
    v_pk_fma_f32 v[48:49], v[46:47], v[32:33], v[48:49] op_sel:[1,1,0] op_sel_hi:[1,0,1] neg_lo:[1,0,0]
    v_cvt_pk_bf16_f32 v53, v48, -v49
    ds_write_addtid_b32 v53 offset:62384
    v_pk_mul_f32 v[46:47], v[48:49], v[32:33] op_sel:[0,0] op_sel_hi:[0,1]
    v_pk_fma_f32 v[46:47], v[48:49], v[32:33], v[46:47] op_sel:[1,1,0] op_sel_hi:[1,0,1] neg_lo:[1,0,0]
    v_cvt_pk_bf16_f32 v50, v46, -v47
    ds_write_addtid_b32 v50 offset:62928
    v_pk_mul_f32 v[48:49], v[46:47], v[32:33] op_sel:[0,0] op_sel_hi:[0,1]
    v_pk_fma_f32 v[48:49], v[46:47], v[32:33], v[48:49] op_sel:[1,1,0] op_sel_hi:[1,0,1] neg_lo:[1,0,0]
    v_cvt_pk_bf16_f32 v51, v48, -v49
    ds_write_addtid_b32 v51 offset:63472
    v_pk_mul_f32 v[46:47], v[48:49], v[32:33] op_sel:[0,0] op_sel_hi:[0,1]
    v_pk_fma_f32 v[46:47], v[48:49], v[32:33], v[46:47] op_sel:[1,1,0] op_sel_hi:[1,0,1] neg_lo:[1,0,0]
    v_cvt_pk_bf16_f32 v52, v46, -v47
    ds_write_addtid_b32 v52 offset:64016
    v_pk_mul_f32 v[48:49], v[46:47], v[32:33] op_sel:[0,0] op_sel_hi:[0,1]
    v_pk_fma_f32 v[48:49], v[46:47], v[32:33], v[48:49] op_sel:[1,1,0] op_sel_hi:[1,0,1] neg_lo:[1,0,0]
    v_cvt_pk_bf16_f32 v53, v48, -v49
    ds_write_addtid_b32 v53 offset:64560
    v_pk_mul_f32 v[46:47], v[48:49], v[32:33] op_sel:[0,0] op_sel_hi:[0,1]
    v_pk_fma_f32 v[46:47], v[48:49], v[32:33], v[46:47] op_sel:[1,1,0] op_sel_hi:[1,0,1] neg_lo:[1,0,0]
    v_cvt_pk_bf16_f32 v50, v46, -v47
    ds_write_addtid_b32 v50 offset:61024
    v_pk_mul_f32 v[48:49], v[46:47], v[32:33] op_sel:[0,0] op_sel_hi:[0,1]
    v_pk_fma_f32 v[48:49], v[46:47], v[32:33], v[48:49] op_sel:[1,1,0] op_sel_hi:[1,0,1] neg_lo:[1,0,0]
    v_cvt_pk_bf16_f32 v51, v48, -v49
    ds_write_addtid_b32 v51 offset:61568
    v_pk_mul_f32 v[46:47], v[48:49], v[32:33] op_sel:[0,0] op_sel_hi:[0,1]
    v_pk_fma_f32 v[46:47], v[48:49], v[32:33], v[46:47] op_sel:[1,1,0] op_sel_hi:[1,0,1] neg_lo:[1,0,0]
    v_cvt_pk_bf16_f32 v52, v46, -v47
    ds_write_addtid_b32 v52 offset:62112
    v_pk_mul_f32 v[48:49], v[46:47], v[32:33] op_sel:[0,0] op_sel_hi:[0,1]
    v_pk_fma_f32 v[48:49], v[46:47], v[32:33], v[48:49] op_sel:[1,1,0] op_sel_hi:[1,0,1] neg_lo:[1,0,0]
    v_cvt_pk_bf16_f32 v53, v48, -v49
    ds_write_addtid_b32 v53 offset:62656
    s_mov_b64 exec, 1
    ds_add_u32 v168, v16 offset:48
    s_mov_b64 exec, -1
    s_setprio 0
    s_lshr_b32 s55, s40, 2
    s_lshl_b32 s55, s55, 14
    s_and_b32 s56, s40, 3
    s_lshl_b32 s56, s56, 11
    s_add_u32 s55, s55, s56
    s_add_u32 s55, s55, 3145728
    v_add_u32 v188, s55, v179
    v_add_u32 v191, 0x2000, v188
    s_lshr_b32 s55, s40, 6
    s_lshl_b32 s55, s55, 13
    s_lshl_b32 s56, s40, 7
    s_add_u32 s55, s55, s56
    s_add_u32 s55, s55, 2097152
    v_and_b32 v24, 8, v1
    v_mul_u32_u24 v24, 1008, v24
    v_add3_u32 v189, v24, v18, s55
    v_add_u32 v190, 65536, v189
    v_lshrrev_b32 v169, 2, v1
    s_cmp_lt_u32 s50, 2
    s_cselect_b32 s57, 3072, 0
    v_mul_u32_u24 v169, s57, v169
    v_lshl_add_u32 v169, v1, 7, v169
    s_mul_i32 s55, s39, 57344
    s_lshl_b32 s56, s38, 9
    s_add_u32 s55, s55, s56
    s_lshl_b32 s56, s41, 13
    s_cmp_lt_u32 s50, 2
    s_cselect_b32 s55, s55, s56
    v_add_u32 v169, s55, v169
    s_cmp_eq_u32 s50, 1
    s_cselect_b64 s[22:23], s[28:29], s[30:31]
    s_cmp_eq_u32 s50, 0
    s_cselect_b64 s[22:23], s[26:27], s[22:23]
    s_add_u32 s55, s50, 4
    s_max_u32 s51, s55, s38
    s_setprio 2
    s_waitcnt vmcnt(0)
    v_xor_b32 v180, v180, v196
    v_xor_b32 v181, v181, v197
    v_xor_b32 v182, v182, v198
    v_xor_b32 v183, v183, v199
    v_xor_b32 v184, v184, v196
    v_xor_b32 v185, v185, v197
    v_xor_b32 v186, v186, v198
    v_xor_b32_e64 v187, v187, v199
    v_or3_b32 v176, v180, v181, v182
    v_or3_b32 v13, v183, v184, v185
    v_or3_b32 v176, v176, v186, v187
    v_bitop3_b32 v176, v176, v13, s52 bitop3:0xa8
    v_cmp_ne_u32 vcc, 0, v176
    s_nop 0
    s_cbranch_vccnz L_p1_retry
L_p1_ok:
    ds_write_b128 v172, v[180:183]
    ds_write_b128 v172, v[184:187] offset:512
    s_mov_b64 exec, 1
    ds_add_u32 v11, v16 offset:320
    s_mov_b64 exec, -1
    s_setprio 0
    v_lshrrev_b32 v40, 16, v241
    v_and_b32 v41, 0xffff, v242
    v_lshrrev_b32 v42, 16, v242
    v_and_b32 v43, 0xffff, v243
    v_lshrrev_b32 v44, 16, v243
    s_lshr_b32 s55, s50, 1
    s_lshl_b32 s55, s55, 2
    v_mov_b32 v45, s55
    s_mov_b32 s54, 0
L_spf:
    ds_read_b32 v46, v11 offset:320
    s_add_u32 s54, s54, 1
    s_cmp_gt_u32 s54, 1048576
    s_waitcnt lgkmcnt(0)
    v_cmp_gt_u32 vcc, 4, v46
    s_cbranch_scc1 L_spf_x
    s_cbranch_vccnz L_spf
L_spf_x:
    s_cmp_eq_u32 s51, 7
    s_cbranch_scc1 L_I_npf
    global_load_dword v255, v169, s[22:23]
L_I_npf:
    s_mov_b32 s54, 0
L_stb:
    ds_read_b32 v46, v45 offset:324
    ds_read_b64 v[24:25], v40
    ds_read_b64 v[26:27], v41
    ds_read_b64 v[28:29], v42
    ds_read_b64 v[30:31], v43
    s_add_u32 s54, s54, 1
    s_cmp_gt_u32 s54, 1048576
    s_waitcnt lgkmcnt(0)
    v_cmp_gt_u32 vcc, 2, v46
    s_cbranch_scc1 L_stb_x
    s_cbranch_vccnz L_stb
L_stb_x:
    v_add_f32 v24, v24, v25
    v_add_f32 v26, v26, v27
    v_add_f32 v28, v28, v29
    v_add_f32 v30, v30, v31
    v_cvt_pk_bf16_f32 v68, v28, v26
    v_cvt_pk_bf16_f32 v69, v26, v26
    v_cvt_pk_bf16_f32 v70, v26, v26
    v_cvt_pk_bf16_f32 v71, v26, v24
    ds_write_b128 v44, v[68:71] offset:4608
    v_cvt_pk_bf16_f32 v72, v30, v28
    v_cvt_pk_bf16_f32 v73, v26, v26
    v_cvt_pk_bf16_f32 v74, v26, v26
    v_cvt_pk_bf16_f32 v75, v26, v26
    ds_write_b128 v44, v[72:75] offset:4672
    v_cvt_pk_bf16_f32 v76, v30, v30
    v_cvt_pk_bf16_f32 v77, v28, v26
    v_cvt_pk_bf16_f32 v78, v26, v26
    v_cvt_pk_bf16_f32 v79, v26, v26
    ds_write_b128 v44, v[76:79] offset:4736
    v_cvt_pk_bf16_f32 v80, v30, v30
    v_cvt_pk_bf16_f32 v81, v30, v28
    v_cvt_pk_bf16_f32 v82, v26, v26
    v_cvt_pk_bf16_f32 v83, v26, v26
    ds_write_b128 v44, v[80:83] offset:4800
    v_not_b32 v192, v196
    global_store_dwordx4 v126, v[192:195], s[36:37] sc1
    global_store_dwordx4 v127, v[192:195], s[36:37] sc1
    s_branch L_I_sh
L_I_spare:
    s_mov_b64 exec, 1
    ds_write_b32 v11, v19 offset:28
    s_mov_b64 exec, 1
    ds_add_u32 v11, v16 offset:16
    s_mov_b64 exec, -1
    s_lshr_b32 s55, s40, 2
    s_lshl_b32 s55, s55, 14
    s_and_b32 s56, s40, 3
    s_lshl_b32 s56, s56, 11
    s_add_u32 s55, s55, s56
    s_add_u32 s55, s55, 3145728
    v_add_u32 v188, s55, v179
    v_add_u32 v191, 0x2000, v188
    s_lshr_b32 s55, s40, 6
    s_lshl_b32 s55, s55, 13
    s_lshl_b32 s56, s40, 7
    s_add_u32 s55, s55, s56
    s_add_u32 s55, s55, 2097152
    v_and_b32 v24, 8, v1
    v_mul_u32_u24 v24, 1008, v24
    v_add3_u32 v189, v24, v18, s55
    v_add_u32 v190, 65536, v189
L_I_sh:
    s_cmp_lg_u32 s50, 3
    s_cbranch_scc1 L_I_nt
    v_not_b32 v65, v19
    v_not_b32 v67, v19
    s_mov_b64 exec, 0xffff
    global_store_dwordx4 v189, v[64:67], s[36:37] sc1
    global_store_dwordx4 v190, v[64:67], s[36:37] sc1
L_I_nt:
    s_mov_b64 exec, s[48:49]
    global_load_dwordx4 v[224:227], v179, s[20:21]
    global_load_dwordx4 v[228:231], v179, s[20:21] offset:448
    global_load_dwordx4 v[232:235], v179, s[24:25]
    global_load_dwordx4 v[236:239], v179, s[24:25] offset:448
    s_mov_b64 exec, -1
    s_setprio 2
    s_cmp_lt_u32 s39, 28
    s_cbranch_scc1 L_I_ep
    s_mov_b64 exec, 1
    s_mov_b32 s54, 0
L_p2a:
    global_load_dwordx4 v[64:67], v173, s[36:37] sc1
    global_load_dwordx4 v[68:71], v174, s[36:37] sc1
    s_add_u32 s54, s54, 1
    s_cmp_gt_u32 s54, 262144
    s_waitcnt vmcnt(0)
    s_cbranch_scc1 L_p2a_x
    v_xor_b32 v64, v64, v196
    v_xor_b32 v65, v65, v197
    v_xor_b32 v66, v66, v198
    v_xor_b32 v67, v67, v199
    v_xor_b32 v68, v68, v196
    v_xor_b32 v69, v69, v197
    v_xor_b32 v70, v70, v198
    v_xor_b32 v71, v71, v199
    v_or3_b32 v176, v64, v65, v66
    v_or3_b32 v13, v67, v68, v69
    v_or3_b32 v176, v176, v70, v71
    v_bitop3_b32 v176, v176, v13, s52 bitop3:0xa8
    v_cmp_ne_u32 vcc, 0, v176
    s_nop 0
    s_and_b64 exec, exec, vcc
    s_cbranch_execnz L_p2a
L_p2a_x:
    s_mov_b64 exec, -1
    s_branch L_x2
L_I_ep:
    s_waitcnt lgkmcnt(0)
    s_barrier
    ds_read_b128 v[24:27], v17 offset:0
    ds_read_b128 v[28:31], v17 offset:14416
    ds_read_b128 v[32:35], v17 offset:28832
    ds_read_b128 v[36:39], v17 offset:43248
    s_waitcnt lgkmcnt(2)
    v_pk_add_f32 v[24:25], v[24:25], v[28:29]
    v_pk_add_f32 v[26:27], v[26:27], v[30:31]
    s_waitcnt lgkmcnt(0)
    v_pk_add_f32 v[32:33], v[32:33], v[36:37]
    v_pk_add_f32 v[34:35], v[34:35], v[38:39]
    v_cvt_pk_bf16_f32 v28, v24, v32
    v_cvt_pk_bf16_f32 v29, v25, v33
    v_cvt_pk_bf16_f32 v30, v26, v34
    v_cvt_pk_bf16_f32 v31, v27, v35
    v_bfi_b32 v28, s52, v196, v28
    v_bfi_b32 v29, s52, v197, v29
    v_bfi_b32 v30, s52, v198, v30
    v_bfi_b32 v31, s52, v199, v31
    global_store_dwordx4 v126, v[28:31], s[36:37] sc1
    s_lshl_b32 s55, s2, 3
    s_add_u32 s55, s55, s42
    s_cmp_lg_u32 s55, 4
    s_cbranch_scc1 L_I_ne
    s_mov_b64 exec, 1
    global_store_dword v11, v19, s[36:37] sc1
    s_mov_b64 exec, -1
L_I_ne:
    s_barrier
    ds_read_b128 v[24:27], v17 offset:4096
    ds_read_b128 v[28:31], v17 offset:18512
    ds_read_b128 v[32:35], v17 offset:32928
    ds_read_b128 v[36:39], v17 offset:47344
    s_waitcnt lgkmcnt(2)
    v_pk_add_f32 v[24:25], v[24:25], v[28:29]
    v_pk_add_f32 v[26:27], v[26:27], v[30:31]
    s_waitcnt lgkmcnt(0)
    s_nop 0
    v_pk_add_f32 v[32:33], v[32:33], v[36:37]
    v_pk_add_f32 v[34:35], v[34:35], v[38:39]
    v_cvt_pk_bf16_f32 v28, v24, v32
    v_cvt_pk_bf16_f32 v29, v25, v33
    v_cvt_pk_bf16_f32 v30, v26, v34
    v_cvt_pk_bf16_f32 v31, v27, v35
    v_bfi_b32 v28, s52, v196, v28
    v_bfi_b32 v29, s52, v197, v29
    v_bfi_b32 v30, s52, v198, v30
    v_bfi_b32 v31, s52, v199, v31
    global_store_dwordx4 v127, v[28:31], s[36:37] sc1
L_x2:
    s_waitcnt vmcnt(0)
    v_add_f32 v148, v148, v144
    v_mov_b32_e64 v149, 0
    v_pk_add_f32 v[128:129], v[128:129], v[144:145] op_sel_hi:[1,0] neg_lo:[0,1] neg_hi:[0,1]
    v_pk_add_f32 v[130:131], v[130:131], v[144:145] op_sel_hi:[1,0] neg_lo:[0,1] neg_hi:[0,1]
    v_pk_add_f32 v[132:133], v[132:133], v[144:145] op_sel_hi:[1,0] neg_lo:[0,1] neg_hi:[0,1]
    v_pk_add_f32 v[134:135], v[134:135], v[144:145] op_sel_hi:[1,0] neg_lo:[0,1] neg_hi:[0,1]
    v_pk_add_f32 v[136:137], v[136:137], v[144:145] op_sel_hi:[1,0] neg_lo:[0,1] neg_hi:[0,1]
    v_pk_add_f32 v[138:139], v[138:139], v[144:145] op_sel_hi:[1,0] neg_lo:[0,1] neg_hi:[0,1]
    v_pk_add_f32 v[140:141], v[140:141], v[144:145] op_sel_hi:[1,0] neg_lo:[0,1] neg_hi:[0,1]
    v_pk_add_f32 v[142:143], v[142:143], v[144:145] op_sel_hi:[1,0] neg_lo:[0,1] neg_hi:[0,1]
    v_lshlrev_b32 v40, 16, v224
    v_and_b32 v41, 0xffff0000, v224
    v_lshlrev_b32 v42, 16, v225
    v_and_b32 v43, 0xffff0000, v225
    v_lshlrev_b32 v44, 16, v226
    v_and_b32 v45, 0xffff0000, v226
    v_lshlrev_b32 v46, 16, v227
    v_and_b32 v47, 0xffff0000, v227
    v_lshlrev_b32 v48, 16, v228
    v_and_b32 v49, 0xffff0000, v228
    v_lshlrev_b32 v50, 16, v229
    v_and_b32 v51, 0xffff0000, v229
    v_lshlrev_b32 v52, 16, v230
    v_and_b32 v53, 0xffff0000, v230
    v_lshlrev_b32 v54, 16, v231
    v_and_b32 v55, 0xffff0000, v231
    s_mov_b32 s60, 0x3f803f80
    s_mov_b64 exec, s[48:49]
    s_nop 0
    v_dot2_f32_bf16 v149, v232, s60, v149
    v_dot2_f32_bf16 v149, v233, s60, v149
    v_dot2_f32_bf16 v149, v234, s60, v149
    v_dot2_f32_bf16 v149, v235, s60, v149
    v_dot2_f32_bf16 v149, v236, s60, v149
    v_dot2_f32_bf16 v149, v237, s60, v149
    v_dot2_f32_bf16 v149, v238, s60, v149
    v_dot2_f32_bf16 v149, v239, s60, v149
    s_mov_b64 exec, -1
    s_nop 0
    v_pk_fma_f32 v[40:41], v[40:41], v[146:147], 1.0 op_sel_hi:[1,0,0]
    v_pk_fma_f32 v[42:43], v[42:43], v[146:147], 1.0 op_sel_hi:[1,0,0]
    v_pk_fma_f32 v[44:45], v[44:45], v[146:147], 1.0 op_sel_hi:[1,0,0]
    v_pk_fma_f32 v[46:47], v[46:47], v[146:147], 1.0 op_sel_hi:[1,0,0]
    v_pk_fma_f32 v[48:49], v[48:49], v[146:147], 1.0 op_sel_hi:[1,0,0]
    v_pk_fma_f32 v[50:51], v[50:51], v[146:147], 1.0 op_sel_hi:[1,0,0]
    v_pk_fma_f32 v[52:53], v[52:53], v[146:147], 1.0 op_sel_hi:[1,0,0]
    v_pk_fma_f32 v[54:55], v[54:55], v[146:147], 1.0 op_sel_hi:[1,0,0]
    v_add_f32_dpp v149, v149, v149 row_ror:8 row_mask:0xf bank_mask:0xf
    v_lshlrev_b32 v150, 16, v232
    v_and_b32 v151, 0xffff0000, v232
    v_add_f32_dpp v149, v149, v149 row_ror:4 row_mask:0xf bank_mask:0xf
    v_lshlrev_b32 v152, 16, v233
    v_and_b32 v153, 0xffff0000, v233
    v_add_f32_dpp v149, v149, v149 row_ror:2 row_mask:0xf bank_mask:0xf
    v_lshlrev_b32 v154, 16, v234
    v_and_b32 v155, 0xffff0000, v234
    v_add_f32_dpp v149, v149, v149 row_ror:1 row_mask:0xf bank_mask:0xf
    v_lshlrev_b32 v156, 16, v235
    v_and_b32 v157, 0xffff0000, v235
    v_add_f32_dpp v149, v149, v149 row_bcast:15 row_mask:0xa bank_mask:0xf
    v_lshlrev_b32 v158, 16, v236
    v_and_b32 v159, 0xffff0000, v236
    v_lshlrev_b32 v160, 16, v237
    v_and_b32 v161, 0xffff0000, v237
    v_lshlrev_b32 v162, 16, v238
    v_and_b32 v163, 0xffff0000, v238
    v_lshlrev_b32 v164, 16, v239
    v_and_b32 v165, 0xffff0000, v239
    v_pk_mul_f32 v[128:129], v[128:129], v[40:41]
    v_pk_mul_f32 v[130:131], v[130:131], v[42:43]
    v_pk_mul_f32 v[132:133], v[132:133], v[44:45]
    v_pk_mul_f32 v[134:135], v[134:135], v[46:47]
    v_pk_mul_f32 v[136:137], v[136:137], v[48:49]
    v_pk_mul_f32 v[138:139], v[138:139], v[50:51]
    v_pk_mul_f32 v[140:141], v[140:141], v[52:53]
    v_pk_mul_f32 v[142:143], v[142:143], v[54:55]
    s_mov_b64 exec, s[46:47]
    global_load_dwordx4 v[64:67], v173, s[36:37] sc1
    global_load_dwordx4 v[68:71], v174, s[36:37] sc1
    s_mov_b64 exec, -1
    v_mov_b32 v120, 0
    v_mov_b32 v121, 0
    v_mov_b32 v124, 0
    v_mov_b32 v99, s43
    v_mov_b32 v103, s43
    v_mov_b32 v107, s43
    v_mov_b32 v109, s43
    v_mov_b32 v111, s43
    s_mov_b32 s94, 0x6f00
    s_mov_b32 s95, 0x6f000000
    s_mov_b32 s60, 0xfffff800
    s_mov_b64 exec, s[46:47]
    s_waitcnt vmcnt(0)
    v_xor_b32 v64, v64, v196
    v_xor_b32 v65, v65, v197
    v_xor_b32 v66, v66, v198
    v_xor_b32 v67, v67, v199
    v_xor_b32 v68, v68, v196
    v_xor_b32 v69, v69, v197
    v_xor_b32 v70, v70, v198
    v_xor_b32 v71, v71, v199
    v_or3_b32 v176, v64, v65, v66
    v_or3_b32 v13, v67, v68, v69
    v_or3_b32 v176, v176, v70, v71
    v_bitop3_b32 v176, v176, v13, s52 bitop3:0xa8
    v_cmp_ne_u32 vcc, 0, v176
    s_nop 0
    s_cbranch_vccnz L_p2_retry
L_p2_ok:
    ds_write2_b32 v200, v64, v68 offset1:28
    ds_write2_b32 v201, v65, v69 offset1:28
    ds_write2_b32 v202, v66, v70 offset1:28
    ds_write2_b32 v203, v67, v71 offset1:28
    s_mov_b64 exec, 1
    ds_add_u32 v11, v16 offset:12
    s_mov_b64 exec, -1
    s_mov_b32 s54, 0
L_syt:
    ds_read_b32 v72, v11 offset:12
    ds_read_b128 v[64:67], v166
    ds_read_b128 v[68:71], v166 offset:448
    s_add_u32 s54, s54, 1
    s_cmp_gt_u32 s54, 1048576
    s_waitcnt lgkmcnt(0)
    v_cmp_gt_u32 vcc, 4, v72
    s_cbranch_scc1 L_syt_x
    s_cbranch_vccnz L_syt
L_syt_x:
    s_mov_b64 exec, s[48:49]
    v_dot2_f32_bf16 v24, v64, s94, v128
    v_dot2_f32_bf16 v25, v64, s95, v129
    v_dot2_f32_bf16 v26, v65, s94, v130
    v_dot2_f32_bf16 v27, v65, s95, v131
    v_dot2_f32_bf16 v28, v66, s94, v132
    v_dot2_f32_bf16 v29, v66, s95, v133
    v_dot2_f32_bf16 v30, v67, s94, v134
    v_dot2_f32_bf16 v31, v67, s95, v135
    v_dot2_f32_bf16 v32, v68, s94, v136
    v_dot2_f32_bf16 v33, v68, s95, v137
    v_dot2_f32_bf16 v34, v69, s94, v138
    v_dot2_f32_bf16 v35, v69, s95, v139
    v_dot2_f32_bf16 v36, v70, s94, v140
    v_dot2_f32_bf16 v37, v70, s95, v141
    v_dot2_f32_bf16 v38, v71, s94, v142
    v_dot2_f32_bf16 v39, v71, s95, v143
    v_pk_add_f32 v[116:117], v[24:25], v[26:27]
    v_pk_mul_f32 v[118:119], v[24:25], v[24:25]
    v_pk_mul_f32 v[122:123], v[24:25], v[150:151]
    v_pk_fma_f32 v[118:119], v[26:27], v[26:27], v[118:119]
    v_pk_fma_f32 v[122:123], v[26:27], v[152:153], v[122:123]
    v_pk_add_f32 v[116:117], v[116:117], v[28:29]
    v_pk_fma_f32 v[118:119], v[28:29], v[28:29], v[118:119]
    v_pk_fma_f32 v[122:123], v[28:29], v[154:155], v[122:123]
    v_pk_add_f32 v[116:117], v[116:117], v[30:31]
    v_pk_fma_f32 v[118:119], v[30:31], v[30:31], v[118:119]
    v_pk_fma_f32 v[122:123], v[30:31], v[156:157], v[122:123]
    v_pk_add_f32 v[116:117], v[116:117], v[32:33]
    v_pk_fma_f32 v[118:119], v[32:33], v[32:33], v[118:119]
    v_pk_fma_f32 v[122:123], v[32:33], v[158:159], v[122:123]
    v_pk_add_f32 v[116:117], v[116:117], v[34:35]
    v_pk_fma_f32 v[118:119], v[34:35], v[34:35], v[118:119]
    v_pk_fma_f32 v[122:123], v[34:35], v[160:161], v[122:123]
    v_pk_add_f32 v[116:117], v[116:117], v[36:37]
    v_pk_fma_f32 v[118:119], v[36:37], v[36:37], v[118:119]
    v_pk_fma_f32 v[122:123], v[36:37], v[162:163], v[122:123]
    v_pk_add_f32 v[116:117], v[116:117], v[38:39]
    v_pk_fma_f32 v[118:119], v[38:39], v[38:39], v[118:119]
    v_pk_fma_f32 v[122:123], v[38:39], v[164:165], v[122:123]
    v_add_f32 v120, v116, v117
    v_add_f32 v121, v118, v119
    v_add_f32 v124, v122, v123
    s_mov_b64 exec, -1
    v_add_f32_dpp v120, v120, v120 row_ror:8 row_mask:0xf bank_mask:0xf
    v_add_f32_dpp v121, v121, v121 row_ror:8 row_mask:0xf bank_mask:0xf
    v_add_f32_dpp v124, v124, v124 row_ror:8 row_mask:0xf bank_mask:0xf
    v_add_f32_dpp v120, v120, v120 row_ror:4 row_mask:0xf bank_mask:0xf
    v_add_f32_dpp v121, v121, v121 row_ror:4 row_mask:0xf bank_mask:0xf
    v_add_f32_dpp v124, v124, v124 row_ror:4 row_mask:0xf bank_mask:0xf
    v_add_f32_dpp v120, v120, v120 row_ror:2 row_mask:0xf bank_mask:0xf
    v_add_f32_dpp v121, v121, v121 row_ror:2 row_mask:0xf bank_mask:0xf
    v_add_f32_dpp v124, v124, v124 row_ror:2 row_mask:0xf bank_mask:0xf
    v_add_f32_dpp v120, v120, v120 row_ror:1 row_mask:0xf bank_mask:0xf
    v_add_f32_dpp v121, v121, v121 row_ror:1 row_mask:0xf bank_mask:0xf
    v_add_f32_dpp v124, v124, v124 row_ror:1 row_mask:0xf bank_mask:0xf
    v_add_f32_dpp v120, v120, v120 row_bcast:15 row_mask:0xa bank_mask:0xf
    v_add_f32_dpp v121, v121, v121 row_bcast:15 row_mask:0xa bank_mask:0xf
    v_add_f32_dpp v124, v124, v124 row_bcast:15 row_mask:0xa bank_mask:0xf
    v_mul_f32 v120, 0x3b124925, v120
    v_mul_f32 v121, 0x3b124925, v121
    v_fma_f32 v121, -v120, v120, v121
    v_fma_f32 v124, -v120, v149, v124
    v_max_f32 v121, 0, v121
    v_add_f32 v121, 0x3727c5ac, v121
    v_rsq_f32 v48, v121
    v_ashrrev_i32 v116, 31, v124
    v_mul_f32 v124, v124, v48
    v_or_b32 v116, 0x80000000, v116
    v_xor_b32 v116, v116, v124
    v_and_or_b32 v116, v116, s60, v178
    v_mul_f32 v50, v120, v48
    v_readlane_b32 s55, v116, 31
    v_readlane_b32 s56, v116, 63
    v_mov_b32 v116, v48
    s_max_u32 s59, s55, s56
    s_cselect_b32 s57, -1, 0
    s_max_u32 s59, s59, 1
    v_mov_b32 v108, s59
    s_mov_b64 exec, 1
    ds_write_b32 v168, v108 offset:32
    s_mov_b64 exec, -1
    s_mov_b32 s54, 0
L_key:
    ds_read_b128 v[56:59], v11 offset:32
    v_mov_b32 v110, s59
    s_add_u32 s54, s54, 1
    s_cmp_gt_u32 s54, 1048576
    s_waitcnt lgkmcnt(0)
    v_min3_u32 v60, v56, v57, v58
    v_max3_u32 v61, v56, v57, v58
    v_min_u32 v60, v60, v59
    v_max_u32 v61, v61, v59
    v_cmp_eq_u32 vcc, 0, v60
    s_cbranch_scc1 L_key_x
    s_cbranch_vccnz L_key
L_key_x:
    v_cmp_ne_u32 vcc, v61, v108
    s_mov_b64 exec, 0xffff
    s_cbranch_vccnz L_nb0
    global_store_dwordx4 v189, v[108:111], s[36:37] sc1
L_nb0:
    s_mov_b64 exec, -1
    v_mov_b32 v117, v50
    s_mov_b32 s58, 0
    v_permlane16_swap_b32 v116, v48
    v_permlane16_swap_b32 v117, v50
    s_cbranch_vccnz L_notbest
    s_mov_b32 exec_lo, s57
    s_not_b32 exec_hi, s57
    v_pk_fma_f32 v[72:73], v[24:25], v[48:49], v[50:51] op_sel_hi:[1,0,0] neg_lo:[0,0,1] neg_hi:[0,0,1]
    v_pk_fma_f32 v[74:75], v[26:27], v[48:49], v[50:51] op_sel_hi:[1,0,0] neg_lo:[0,0,1] neg_hi:[0,0,1]
    v_pk_fma_f32 v[76:77], v[28:29], v[48:49], v[50:51] op_sel_hi:[1,0,0] neg_lo:[0,0,1] neg_hi:[0,0,1]
    v_pk_fma_f32 v[78:79], v[30:31], v[48:49], v[50:51] op_sel_hi:[1,0,0] neg_lo:[0,0,1] neg_hi:[0,0,1]
    v_pk_fma_f32 v[80:81], v[32:33], v[48:49], v[50:51] op_sel_hi:[1,0,0] neg_lo:[0,0,1] neg_hi:[0,0,1]
    v_pk_fma_f32 v[82:83], v[34:35], v[48:49], v[50:51] op_sel_hi:[1,0,0] neg_lo:[0,0,1] neg_hi:[0,0,1]
    v_pk_fma_f32 v[84:85], v[36:37], v[48:49], v[50:51] op_sel_hi:[1,0,0] neg_lo:[0,0,1] neg_hi:[0,0,1]
    v_pk_fma_f32 v[86:87], v[38:39], v[48:49], v[50:51] op_sel_hi:[1,0,0] neg_lo:[0,0,1] neg_hi:[0,0,1]
    v_cvt_pk_bf16_f32 v96, v72, v73
    v_cvt_pk_bf16_f32 v97, v74, v75
    v_cvt_pk_bf16_f32 v98, v76, v77
    v_cvt_pk_bf16_f32 v100, v78, v79
    v_cvt_pk_bf16_f32 v101, v80, v81
    v_cvt_pk_bf16_f32 v102, v82, v83
    v_cvt_pk_bf16_f32 v104, v84, v85
    v_cvt_pk_bf16_f32 v105, v86, v87
    v_fma_f32 v121, v121, v48, 1.0
    v_add_f32_e64 v120, v120, v148
    s_mov_b32 s60, 0x10000
    s_mov_b32 s61, 0x10000
    v_cndmask_b32 v106, v121, v124, s[60:61]
    s_mov_b32 s60, 0x20000
    s_mov_b32 s61, 0x20000
    v_cndmask_b32 v106, v106, v120, s[60:61]
    global_store_dwordx4 v188, v[96:99], s[36:37] offset:0 sc1
    global_store_dwordx4 v188, v[100:103], s[36:37] offset:512 sc1
    global_store_dwordx4 v188, v[104:107], s[36:37] offset:1024 sc1
    global_store_dwordx4 v191, v[96:99], s[36:37] offset:0 sc1
    global_store_dwordx4 v191, v[100:103], s[36:37] offset:512 sc1
    global_store_dwordx4 v191, v[104:107], s[36:37] offset:1024 sc1
    s_mov_b64 exec, -1
    s_mov_b32 s58, 1
L_notbest:
    v_add_f32 v52, 1.0, v48
    v_sub_f32 v54, v148, v50
    v_pk_fma_f32 v[24:25], v[24:25], v[52:53], v[54:55] op_sel_hi:[1,0,0]
    v_pk_fma_f32 v[26:27], v[26:27], v[52:53], v[54:55] op_sel_hi:[1,0,0]
    v_pk_fma_f32 v[28:29], v[28:29], v[52:53], v[54:55] op_sel_hi:[1,0,0]
    v_pk_fma_f32 v[30:31], v[30:31], v[52:53], v[54:55] op_sel_hi:[1,0,0]
    v_pk_fma_f32 v[32:33], v[32:33], v[52:53], v[54:55] op_sel_hi:[1,0,0]
    v_pk_fma_f32 v[34:35], v[34:35], v[52:53], v[54:55] op_sel_hi:[1,0,0]
    v_pk_fma_f32 v[36:37], v[36:37], v[52:53], v[54:55] op_sel_hi:[1,0,0]
    v_pk_fma_f32 v[38:39], v[38:39], v[52:53], v[54:55] op_sel_hi:[1,0,0]
    v_cvt_pk_bf16_f32 v64, v24, v25
    v_cvt_pk_bf16_f32 v65, v26, v27
    v_cvt_pk_bf16_f32 v66, v28, v29
    v_cvt_pk_bf16_f32 v67, v30, v31
    v_cvt_pk_bf16_f32 v68, v32, v33
    v_cvt_pk_bf16_f32 v69, v34, v35
    v_cvt_pk_bf16_f32 v70, v36, v37
    v_cvt_pk_bf16_f32 v71, v38, v39
    s_mov_b64 exec, s[48:49]
    global_store_dwordx4 v10, v[64:67], s[32:33] sc1
    global_store_dwordx4 v10, v[68:71], s[32:33] offset:448 sc1
    s_cmp_eq_u32 s58, 0
    s_cbranch_scc1 L_fin
    s_waitcnt vmcnt(8)
    s_mov_b64 exec, 1
    ds_add_u32 v11, v16 offset:24
    s_mov_b64 exec, -1
    s_mov_b64 exec, 0xffff
    s_waitcnt vmcnt(0)
    global_store_dwordx4 v190, v[108:111], s[36:37] sc1
    s_branch L_fin
L_C:
    s_waitcnt lgkmcnt(0)
    s_lshl_b32 s55, s53, 16
    s_and_b32 s56, s53, 0xffff0000
    s_cmp_lt_u32 s50, 2
    s_cselect_b32 s55, s55, s56
    v_mul_f32 v56, s55, v56
    v_exp_f32_e64 v56, v56
    s_nop 0
    v_cvt_pk_bf16_f32 v56, v56, v56
    v_and_b32 v56, 0xffff0000, v56
    v_pk_mul_f32 v[60:61], v[56:57], s[92:93] op_sel_hi:[0,1]
    v_mul_f32 v56, 0x32000000, v56
    s_waitcnt vmcnt(0)
    v_pk_mul_f32 v[58:59], v[216:217], v[60:61]
    v_mul_f32 v42, 0x43800000, v58
    v_mul_f32 v43, 0x43800000, v59
    v_fract_f32 v59, v59
    v_fract_f32 v43, v43
    v_exp_f32 v58, v58
    v_cos_f32 v24, v59
    v_sin_f32 v25, v59
    v_exp_f32 v42, v42
    v_cos_f32 v34, v43
    v_sin_f32_e64 v35, v43
    v_pk_mul_f32 v[24:25], v[24:25], v[58:59] op_sel_hi:[1,0]
    v_cvt_pk_bf16_f32 v50, v24, v25
    ds_write_addtid_b32 v50 offset:2992
    v_pk_mul_f32 v[34:35], v[34:35], v[42:43] op_sel_hi:[1,0]
    v_cvt_pk_bf16_f32 v51, v34, v35
    ds_write_addtid_b32 v51 offset:2176
    global_load_dwordx4 v[224:227], v14, s[44:45]
    global_load_dwordx4 v[228:231], v14, s[44:45] offset:1024
    v_pk_mul_f32 v[26:27], v[24:25], v[24:25] op_sel:[0,0] op_sel_hi:[0,1]
    v_pk_fma_f32 v[26:27], v[24:25], v[24:25], v[26:27] op_sel:[1,1,0] op_sel_hi:[1,0,1] neg_lo:[1,0,0]
    v_cvt_pk_bf16_f32 v52, v26, v27
    ds_write_addtid_b32 v52 offset:3536
    v_pk_mul_f32 v[28:29], v[26:27], v[26:27] op_sel:[0,0] op_sel_hi:[0,1]
    v_pk_fma_f32 v[28:29], v[26:27], v[26:27], v[28:29] op_sel:[1,1,0] op_sel_hi:[1,0,1] neg_lo:[1,0,0]
    v_cvt_pk_bf16_f32 v53, v28, v29
    ds_write_addtid_b32 v53 offset:0
    v_pk_mul_f32 v[30:31], v[28:29], v[26:27] op_sel:[0,0] op_sel_hi:[0,1]
    v_pk_fma_f32 v[30:31], v[28:29], v[26:27], v[30:31] op_sel:[1,1,0] op_sel_hi:[1,0,1] neg_lo:[1,0,0]
    v_cvt_pk_bf16_f32 v50, v30, v31
    ds_write_addtid_b32 v50 offset:1088
    v_pk_mul_f32 v[42:43], v[26:27], v[24:25] op_sel:[0,0] op_sel_hi:[0,1]
    v_pk_fma_f32 v[42:43], v[26:27], v[24:25], v[42:43] op_sel:[1,1,0] op_sel_hi:[1,0,1] neg_lo:[1,0,0]
    v_cvt_pk_bf16_f32 v51, v42, v43
    ds_write_addtid_b32 v51 offset:4080
    v_pk_mul_f32 v[42:43], v[28:29], v[24:25] op_sel:[0,0] op_sel_hi:[0,1]
    v_pk_fma_f32 v[42:43], v[28:29], v[24:25], v[42:43] op_sel:[1,1,0] op_sel_hi:[1,0,1] neg_lo:[1,0,0]
    v_cvt_pk_bf16_f32 v52, v42, v43
    ds_write_addtid_b32 v52 offset:544
    v_pk_mul_f32 v[42:43], v[30:31], v[24:25] op_sel:[0,0] op_sel_hi:[0,1]
    v_pk_fma_f32 v[42:43], v[30:31], v[24:25], v[42:43] op_sel:[1,1,0] op_sel_hi:[1,0,1] neg_lo:[1,0,0]
    v_cvt_pk_bf16_f32 v53, v42, v43
    ds_write_addtid_b32 v53 offset:1632
    v_pk_mul_f32 v[42:43], v[34:35], v[26:27] op_sel:[0,0] op_sel_hi:[0,1]
    v_pk_fma_f32 v[42:43], v[34:35], v[26:27], v[42:43] op_sel:[1,1,0] op_sel_hi:[1,0,1] neg_lo:[1,0,0]
    v_cvt_pk_bf16_f32 v50, v42, v43
    ds_write_addtid_b32 v50 offset:2720
    v_pk_mul_f32 v[42:43], v[34:35], v[28:29] op_sel:[0,0] op_sel_hi:[0,1]
    v_pk_fma_f32 v[42:43], v[34:35], v[28:29], v[42:43] op_sel:[1,1,0] op_sel_hi:[1,0,1] neg_lo:[1,0,0]
    v_cvt_pk_bf16_f32 v51, v42, v43
    ds_write_addtid_b32 v51 offset:3264
    v_pk_mul_f32 v[42:43], v[34:35], v[30:31] op_sel:[0,0] op_sel_hi:[0,1]
    v_pk_fma_f32 v[42:43], v[34:35], v[30:31], v[42:43] op_sel:[1,1,0] op_sel_hi:[1,0,1] neg_lo:[1,0,0]
    v_cvt_pk_bf16_f32 v52, v42, v43
    ds_write_addtid_b32 v52 offset:3808
    v_pk_mul_f32 v[36:37], v[34:35], v[34:35] op_sel:[0,0] op_sel_hi:[0,1]
    v_pk_fma_f32 v[36:37], v[34:35], v[34:35], v[36:37] op_sel:[1,1,0] op_sel_hi:[1,0,1] neg_lo:[1,0,0]
    v_cvt_pk_bf16_f32 v53, v36, v37
    ds_write_addtid_b32 v53 offset:272
    v_pk_mul_f32 v[42:43], v[36:37], v[28:29] op_sel:[0,0] op_sel_hi:[0,1]
    v_pk_fma_f32 v[42:43], v[36:37], v[28:29], v[42:43] op_sel:[1,1,0] op_sel_hi:[1,0,1] neg_lo:[1,0,0]
    v_cvt_pk_bf16_f32 v50, v42, v43
    ds_write_addtid_b32 v50 offset:816
    v_pk_mul_f32 v[38:39], v[36:37], v[34:35] op_sel:[0,0] op_sel_hi:[0,1]
    v_pk_fma_f32 v[38:39], v[36:37], v[34:35], v[38:39] op_sel:[1,1,0] op_sel_hi:[1,0,1] neg_lo:[1,0,0]
    v_cvt_pk_bf16_f32 v51, v38, v39
    ds_write_addtid_b32 v51 offset:1360
    v_pk_mul_f32 v[42:43], v[38:39], v[28:29] op_sel:[0,0] op_sel_hi:[0,1]
    v_pk_fma_f32 v[42:43], v[38:39], v[28:29], v[42:43] op_sel:[1,1,0] op_sel_hi:[1,0,1] neg_lo:[1,0,0]
    v_cvt_pk_bf16_f32 v52, v42, v43
    ds_write_addtid_b32 v52 offset:1904
    v_pk_mul_f32 v[40:41], v[36:37], v[36:37] op_sel:[0,0] op_sel_hi:[0,1]
    v_pk_fma_f32 v[40:41], v[36:37], v[36:37], v[40:41] op_sel:[1,1,0] op_sel_hi:[1,0,1] neg_lo:[1,0,0]
    v_cvt_pk_bf16_f32 v53, v40, v41
    ds_write_addtid_b32 v53 offset:4352
    v_pk_mul_f32 v[42:43], v[40:41], v[34:35] op_sel:[0,0] op_sel_hi:[0,1]
    v_pk_fma_f32 v[42:43], v[40:41], v[34:35], v[42:43] op_sel:[1,1,0] op_sel_hi:[1,0,1] neg_lo:[1,0,0]
    v_cvt_pk_bf16_f32 v50, v42, v43
    ds_write_addtid_b32 v50 offset:4896
    v_pk_mul_f32 v[42:43], v[40:41], v[36:37] op_sel:[0,0] op_sel_hi:[0,1]
    v_pk_fma_f32 v[42:43], v[40:41], v[36:37], v[42:43] op_sel:[1,1,0] op_sel_hi:[1,0,1] neg_lo:[1,0,0]
    v_cvt_pk_bf16_f32 v51, v42, v43
    ds_write_addtid_b32 v51 offset:5440
    v_pk_mul_f32 v[42:43], v[40:41], v[38:39] op_sel:[0,0] op_sel_hi:[0,1]
    v_pk_fma_f32 v[42:43], v[40:41], v[38:39], v[42:43] op_sel:[1,1,0] op_sel_hi:[1,0,1] neg_lo:[1,0,0]
    v_cvt_pk_bf16_f32 v52, v42, v43
    ds_write_addtid_b32 v52 offset:4624
    v_pk_mul_f32 v[42:43], v[40:41], v[40:41] op_sel:[0,0] op_sel_hi:[0,1]
    v_pk_fma_f32 v[42:43], v[40:41], v[40:41], v[42:43] op_sel:[1,1,0] op_sel_hi:[1,0,1] neg_lo:[1,0,0]
    v_cvt_pk_bf16_f32 v53, v42, v43
    ds_write_addtid_b32 v53 offset:5168
    v_pk_mul_f32 v[46:47], v[218:219], v[220:221] op_sel:[0,0] op_sel_hi:[0,1]
    v_pk_fma_f32 v[46:47], v[218:219], v[220:221], v[46:47] op_sel:[1,1,0] op_sel_hi:[1,0,1] neg_lo:[1,0,0]
    v_pk_mul_f32 v[46:47], v[46:47], v[56:57] op_sel_hi:[1,0]
    v_cvt_pk_bf16_f32 v50, v46, -v47
    ds_write_addtid_b32 v50 offset:8160
    v_pk_mul_f32 v[32:33], v[28:29], v[28:29] op_sel:[0,0] op_sel_hi:[0,1]
    v_pk_fma_f32 v[32:33], v[28:29], v[28:29], v[32:33] op_sel:[1,1,0] op_sel_hi:[1,0,1] neg_lo:[1,0,0]
    v_pk_mul_f32 v[48:49], v[46:47], v[32:33] op_sel:[0,0] op_sel_hi:[0,1]
    v_pk_fma_f32 v[48:49], v[46:47], v[32:33], v[48:49] op_sel:[1,1,0] op_sel_hi:[1,0,1] neg_lo:[1,0,0]
    v_cvt_pk_bf16_f32 v51, v48, -v49
    ds_write_addtid_b32 v51 offset:8704
    v_pk_mul_f32 v[46:47], v[48:49], v[32:33] op_sel:[0,0] op_sel_hi:[0,1]
    v_pk_fma_f32 v[46:47], v[48:49], v[32:33], v[46:47] op_sel:[1,1,0] op_sel_hi:[1,0,1] neg_lo:[1,0,0]
    v_cvt_pk_bf16_f32 v52, v46, -v47
    ds_write_addtid_b32 v52 offset:9248
    v_pk_mul_f32 v[48:49], v[46:47], v[32:33] op_sel:[0,0] op_sel_hi:[0,1]
    v_pk_fma_f32 v[48:49], v[46:47], v[32:33], v[48:49] op_sel:[1,1,0] op_sel_hi:[1,0,1] neg_lo:[1,0,0]
    v_cvt_pk_bf16_f32 v53, v48, -v49
    ds_write_addtid_b32 v53 offset:9792
    v_pk_mul_f32 v[46:47], v[48:49], v[32:33] op_sel:[0,0] op_sel_hi:[0,1]
    v_pk_fma_f32 v[46:47], v[48:49], v[32:33], v[46:47] op_sel:[1,1,0] op_sel_hi:[1,0,1] neg_lo:[1,0,0]
    v_cvt_pk_bf16_f32 v50, v46, -v47
    ds_write_addtid_b32 v50 offset:5712
    v_pk_mul_f32 v[48:49], v[46:47], v[32:33] op_sel:[0,0] op_sel_hi:[0,1]
    v_pk_fma_f32 v[48:49], v[46:47], v[32:33], v[48:49] op_sel:[1,1,0] op_sel_hi:[1,0,1] neg_lo:[1,0,0]
    v_cvt_pk_bf16_f32 v51, v48, -v49
    ds_write_addtid_b32 v51 offset:6256
    v_pk_mul_f32 v[46:47], v[48:49], v[32:33] op_sel:[0,0] op_sel_hi:[0,1]
    v_pk_fma_f32 v[46:47], v[48:49], v[32:33], v[46:47] op_sel:[1,1,0] op_sel_hi:[1,0,1] neg_lo:[1,0,0]
    v_cvt_pk_bf16_f32 v52, v46, -v47
    ds_write_addtid_b32 v52 offset:6800
    v_pk_mul_f32 v[48:49], v[46:47], v[32:33] op_sel:[0,0] op_sel_hi:[0,1]
    v_pk_fma_f32 v[48:49], v[46:47], v[32:33], v[48:49] op_sel:[1,1,0] op_sel_hi:[1,0,1] neg_lo:[1,0,0]
    v_cvt_pk_bf16_f32 v53, v48, -v49
    ds_write_addtid_b32 v53 offset:7344
    v_pk_mul_f32 v[46:47], v[48:49], v[32:33] op_sel:[0,0] op_sel_hi:[0,1]
    v_pk_fma_f32 v[46:47], v[48:49], v[32:33], v[46:47] op_sel:[1,1,0] op_sel_hi:[1,0,1] neg_lo:[1,0,0]
    v_cvt_pk_bf16_f32 v50, v46, -v47
    ds_write_addtid_b32 v50 offset:7888
    v_pk_mul_f32 v[48:49], v[46:47], v[32:33] op_sel:[0,0] op_sel_hi:[0,1]
    v_pk_fma_f32 v[48:49], v[46:47], v[32:33], v[48:49] op_sel:[1,1,0] op_sel_hi:[1,0,1] neg_lo:[1,0,0]
    v_cvt_pk_bf16_f32 v51, v48, -v49
    ds_write_addtid_b32 v51 offset:8432
    v_pk_mul_f32 v[46:47], v[48:49], v[32:33] op_sel:[0,0] op_sel_hi:[0,1]
    v_pk_fma_f32 v[46:47], v[48:49], v[32:33], v[46:47] op_sel:[1,1,0] op_sel_hi:[1,0,1] neg_lo:[1,0,0]
    v_cvt_pk_bf16_f32 v52, v46, -v47
    ds_write_addtid_b32 v52 offset:8976
    v_pk_mul_f32 v[48:49], v[46:47], v[32:33] op_sel:[0,0] op_sel_hi:[0,1]
    v_pk_fma_f32 v[48:49], v[46:47], v[32:33], v[48:49] op_sel:[1,1,0] op_sel_hi:[1,0,1] neg_lo:[1,0,0]
    v_cvt_pk_bf16_f32 v53, v48, -v49
    ds_write_addtid_b32 v53 offset:9520
    v_pk_mul_f32 v[46:47], v[48:49], v[32:33] op_sel:[0,0] op_sel_hi:[0,1]
    v_pk_fma_f32 v[46:47], v[48:49], v[32:33], v[46:47] op_sel:[1,1,0] op_sel_hi:[1,0,1] neg_lo:[1,0,0]
    v_cvt_pk_bf16_f32 v50, v46, -v47
    ds_write_addtid_b32 v50 offset:5984
    v_pk_mul_f32 v[48:49], v[46:47], v[32:33] op_sel:[0,0] op_sel_hi:[0,1]
    v_pk_fma_f32 v[48:49], v[46:47], v[32:33], v[48:49] op_sel:[1,1,0] op_sel_hi:[1,0,1] neg_lo:[1,0,0]
    v_cvt_pk_bf16_f32 v51, v48, -v49
    ds_write_addtid_b32 v51 offset:6528
    v_pk_mul_f32 v[46:47], v[48:49], v[32:33] op_sel:[0,0] op_sel_hi:[0,1]
    v_pk_fma_f32 v[46:47], v[48:49], v[32:33], v[46:47] op_sel:[1,1,0] op_sel_hi:[1,0,1] neg_lo:[1,0,0]
    v_cvt_pk_bf16_f32 v52, v46, -v47
    ds_write_addtid_b32 v52 offset:7072
    v_pk_mul_f32 v[48:49], v[46:47], v[32:33] op_sel:[0,0] op_sel_hi:[0,1]
    v_pk_fma_f32 v[48:49], v[46:47], v[32:33], v[48:49] op_sel:[1,1,0] op_sel_hi:[1,0,1] neg_lo:[1,0,0]
    v_cvt_pk_bf16_f32 v53, v48, -v49
    ds_write_addtid_b32 v53 offset:7616
    v_pk_mul_f32 v[46:47], v[48:49], v[32:33] op_sel:[0,0] op_sel_hi:[0,1]
    v_pk_fma_f32 v[46:47], v[48:49], v[32:33], v[46:47] op_sel:[1,1,0] op_sel_hi:[1,0,1] neg_lo:[1,0,0]
    v_cvt_pk_bf16_f32 v50, v46, -v47
    ds_write_addtid_b32 v50 offset:12512
    v_pk_mul_f32 v[48:49], v[46:47], v[32:33] op_sel:[0,0] op_sel_hi:[0,1]
    v_pk_fma_f32 v[48:49], v[46:47], v[32:33], v[48:49] op_sel:[1,1,0] op_sel_hi:[1,0,1] neg_lo:[1,0,0]
    v_cvt_pk_bf16_f32 v51, v48, -v49
    ds_write_addtid_b32 v51 offset:13056
    v_pk_mul_f32 v[46:47], v[48:49], v[32:33] op_sel:[0,0] op_sel_hi:[0,1]
    v_pk_fma_f32 v[46:47], v[48:49], v[32:33], v[46:47] op_sel:[1,1,0] op_sel_hi:[1,0,1] neg_lo:[1,0,0]
    v_cvt_pk_bf16_f32 v52, v46, -v47
    ds_write_addtid_b32 v52 offset:13600
    v_pk_mul_f32 v[48:49], v[46:47], v[32:33] op_sel:[0,0] op_sel_hi:[0,1]
    v_pk_fma_f32 v[48:49], v[46:47], v[32:33], v[48:49] op_sel:[1,1,0] op_sel_hi:[1,0,1] neg_lo:[1,0,0]
    v_cvt_pk_bf16_f32 v53, v48, -v49
    ds_write_addtid_b32 v53 offset:14144
    v_pk_mul_f32 v[46:47], v[48:49], v[32:33] op_sel:[0,0] op_sel_hi:[0,1]
    v_pk_fma_f32 v[46:47], v[48:49], v[32:33], v[46:47] op_sel:[1,1,0] op_sel_hi:[1,0,1] neg_lo:[1,0,0]
    v_cvt_pk_bf16_f32 v50, v46, -v47
    ds_write_addtid_b32 v50 offset:10064
    v_pk_mul_f32 v[48:49], v[46:47], v[32:33] op_sel:[0,0] op_sel_hi:[0,1]
    v_pk_fma_f32 v[48:49], v[46:47], v[32:33], v[48:49] op_sel:[1,1,0] op_sel_hi:[1,0,1] neg_lo:[1,0,0]
    v_cvt_pk_bf16_f32 v51, v48, -v49
    ds_write_addtid_b32 v51 offset:10608
    v_pk_mul_f32 v[46:47], v[48:49], v[32:33] op_sel:[0,0] op_sel_hi:[0,1]
    v_pk_fma_f32 v[46:47], v[48:49], v[32:33], v[46:47] op_sel:[1,1,0] op_sel_hi:[1,0,1] neg_lo:[1,0,0]
    v_cvt_pk_bf16_f32 v52, v46, -v47
    ds_write_addtid_b32 v52 offset:11152
    v_pk_mul_f32 v[48:49], v[46:47], v[32:33] op_sel:[0,0] op_sel_hi:[0,1]
    v_pk_fma_f32 v[48:49], v[46:47], v[32:33], v[48:49] op_sel:[1,1,0] op_sel_hi:[1,0,1] neg_lo:[1,0,0]
    v_cvt_pk_bf16_f32 v53, v48, -v49
    ds_write_addtid_b32 v53 offset:11696
    v_pk_mul_f32 v[46:47], v[48:49], v[32:33] op_sel:[0,0] op_sel_hi:[0,1]
    v_pk_fma_f32 v[46:47], v[48:49], v[32:33], v[46:47] op_sel:[1,1,0] op_sel_hi:[1,0,1] neg_lo:[1,0,0]
    v_cvt_pk_bf16_f32 v50, v46, -v47
    ds_write_addtid_b32 v50 offset:12240
    v_pk_mul_f32 v[48:49], v[46:47], v[32:33] op_sel:[0,0] op_sel_hi:[0,1]
    v_pk_fma_f32 v[48:49], v[46:47], v[32:33], v[48:49] op_sel:[1,1,0] op_sel_hi:[1,0,1] neg_lo:[1,0,0]
    v_cvt_pk_bf16_f32 v51, v48, -v49
    ds_write_addtid_b32 v51 offset:12784
    v_pk_mul_f32 v[46:47], v[48:49], v[32:33] op_sel:[0,0] op_sel_hi:[0,1]
    v_pk_fma_f32 v[46:47], v[48:49], v[32:33], v[46:47] op_sel:[1,1,0] op_sel_hi:[1,0,1] neg_lo:[1,0,0]
    v_cvt_pk_bf16_f32 v52, v46, -v47
    ds_write_addtid_b32 v52 offset:13328
    v_pk_mul_f32 v[48:49], v[46:47], v[32:33] op_sel:[0,0] op_sel_hi:[0,1]
    v_pk_fma_f32 v[48:49], v[46:47], v[32:33], v[48:49] op_sel:[1,1,0] op_sel_hi:[1,0,1] neg_lo:[1,0,0]
    v_cvt_pk_bf16_f32 v53, v48, -v49
    ds_write_addtid_b32 v53 offset:13872
    v_pk_mul_f32 v[46:47], v[48:49], v[32:33] op_sel:[0,0] op_sel_hi:[0,1]
    v_pk_fma_f32 v[46:47], v[48:49], v[32:33], v[46:47] op_sel:[1,1,0] op_sel_hi:[1,0,1] neg_lo:[1,0,0]
    v_cvt_pk_bf16_f32 v50, v46, -v47
    ds_write_addtid_b32 v50 offset:10336
    v_pk_mul_f32 v[48:49], v[46:47], v[32:33] op_sel:[0,0] op_sel_hi:[0,1]
    v_pk_fma_f32 v[48:49], v[46:47], v[32:33], v[48:49] op_sel:[1,1,0] op_sel_hi:[1,0,1] neg_lo:[1,0,0]
    v_cvt_pk_bf16_f32 v51, v48, -v49
    ds_write_addtid_b32 v51 offset:10880
    v_pk_mul_f32 v[46:47], v[48:49], v[32:33] op_sel:[0,0] op_sel_hi:[0,1]
    v_pk_fma_f32 v[46:47], v[48:49], v[32:33], v[46:47] op_sel:[1,1,0] op_sel_hi:[1,0,1] neg_lo:[1,0,0]
    v_cvt_pk_bf16_f32 v52, v46, -v47
    ds_write_addtid_b32 v52 offset:11424
    v_pk_mul_f32 v[48:49], v[46:47], v[32:33] op_sel:[0,0] op_sel_hi:[0,1]
    v_pk_fma_f32 v[48:49], v[46:47], v[32:33], v[48:49] op_sel:[1,1,0] op_sel_hi:[1,0,1] neg_lo:[1,0,0]
    v_cvt_pk_bf16_f32 v53, v48, -v49
    ds_write_addtid_b32 v53 offset:11968
    ds_read_b128 v[64:67], v62 offset:0
    ds_read_b128 v[96:99], v62 offset:5712
    ds_read_b128 v[80:83], v62 offset:4352
    ds_read_b128 v[112:115], v62 offset:10064
    ds_read_b128 v[68:71], v62 offset:16
    ds_read_b128 v[100:103], v62 offset:5728
    ds_read_b128 v[84:87], v62 offset:4368
    ds_read_b128 v[116:119], v62 offset:10080
    ds_read_b128 v[72:75], v62 offset:128
    ds_read_b128 v[104:107], v62 offset:5840
    ds_read_b128 v[88:91], v62 offset:4480
    ds_read_b128 v[120:123], v62 offset:10192
    ds_read_b128 v[76:79], v62 offset:144
    ds_read_b128 v[108:111], v62 offset:5856
    ds_read_b128 v[92:95], v62 offset:4496
    ds_read_b128 v[124:127], v62 offset:10208
    s_waitcnt lgkmcnt(12)
    v_mfma_f32_16x16x32_bf16 v[200:203], v[64:67], v[96:99], 0
    s_waitcnt vmcnt(0)
    v_mfma_f32_16x16x32_bf16 v[204:207], v[80:83], v[96:99], 0
    v_and_b32 v136, 0xffff, v224
    v_mfma_f32_16x16x32_bf16 v[208:211], v[64:67], v[112:115], 0
    v_lshrrev_b32 v137, 16, v224
    v_mfma_f32_16x16x32_bf16 v[212:215], v[80:83], v[112:115], 0
    v_and_b32 v138, 0xffff, v225
    s_waitcnt lgkmcnt(8)
    v_mfma_f32_16x16x32_bf16 v[200:203], v[68:71], v[100:103], v[200:203]
    v_lshrrev_b32 v139, 16, v225
    v_mfma_f32_16x16x32_bf16 v[204:207], v[84:87], v[100:103], v[204:207]
    v_and_b32 v140, 0xffff, v226
    v_mfma_f32_16x16x32_bf16 v[208:211], v[68:71], v[116:119], v[208:211]
    v_lshrrev_b32 v141, 16, v226
    v_mfma_f32_16x16x32_bf16 v[212:215], v[84:87], v[116:119], v[212:215]
    v_and_b32 v142, 0xffff, v227
    s_waitcnt lgkmcnt(4)
    v_mfma_f32_16x16x32_bf16 v[200:203], v[72:75], v[104:107], v[200:203]
    v_lshrrev_b32 v143, 16, v227
    v_mfma_f32_16x16x32_bf16 v[204:207], v[88:91], v[104:107], v[204:207]
    v_and_b32 v144, 0xffff, v228
    v_mfma_f32_16x16x32_bf16 v[208:211], v[72:75], v[120:123], v[208:211]
    v_lshrrev_b32 v145, 16, v228
    v_mfma_f32_16x16x32_bf16 v[212:215], v[88:91], v[120:123], v[212:215]
    v_and_b32 v146, 0xffff, v229
    s_waitcnt lgkmcnt(0)
    v_mfma_f32_16x16x32_bf16 v[200:203], v[76:79], v[108:111], v[200:203]
    v_lshrrev_b32_e64 v12, 16, v231
    v_mfma_f32_16x16x32_bf16 v[204:207], v[92:95], v[108:111], v[204:207]
    v_add_u32 v62, 57664, v62
    v_mfma_f32_16x16x32_bf16 v[208:211], v[76:79], v[124:127], v[208:211]
    v_mfma_f32_16x16x32_bf16 v[212:215], v[92:95], v[124:127], v[212:215]
    ds_write_b128 v23, v[8:11]
L_f_again:
    ds_read_b32 v54, v21 offset:48
    ds_read_b128 v[64:67], v62 offset:0
    ds_read_b128 v[96:99], v62 offset:5712
    ds_read_b128 v[80:83], v62 offset:4352
    ds_read_b128 v[68:71], v62 offset:16
    ds_read_b128 v[100:103], v62 offset:5728
    ds_read_b128 v[84:87], v62 offset:4368
    ds_read_b128 v[72:75], v62 offset:128
    ds_read_b128 v[104:107], v62 offset:5840
    ds_read_b128 v[88:91], v62 offset:4480
    ds_read_b128 v[76:79], v62 offset:144
    ds_read_b128 v[108:111], v62 offset:5856
    ds_read_b128 v[92:95], v62 offset:4496
    s_waitcnt lgkmcnt(9)
    v_cmp_eq_u32 vcc, 0, v54
    s_nop 0
    s_cbranch_vccnz L_f_retry
    v_mfma_f32_16x16x32_bf16 v[200:203], v[64:67], v[96:99], v[200:203]
    v_mfma_f32_16x16x32_bf16 v[204:207], v[80:83], v[96:99], v[204:207]
    s_waitcnt lgkmcnt(6)
    v_mfma_f32_16x16x32_bf16 v[200:203], v[68:71], v[100:103], v[200:203]
    v_mfma_f32_16x16x32_bf16 v[204:207], v[84:87], v[100:103], v[204:207]
    s_waitcnt lgkmcnt(3)
    v_mfma_f32_16x16x32_bf16 v[200:203], v[72:75], v[104:107], v[200:203]
    v_mfma_f32_16x16x32_bf16 v[204:207], v[88:91], v[104:107], v[204:207]
    s_waitcnt lgkmcnt(0)
    v_mfma_f32_16x16x32_bf16 v[200:203], v[76:79], v[108:111], v[200:203]
    v_mfma_f32_16x16x32_bf16 v[204:207], v[92:95], v[108:111], v[204:207]
    s_nop 6
    ds_write_b32 v63, v200 offset:1408
    ds_write_b32 v63, v201 offset:1664
    ds_write_b32 v63, v202 offset:1920
    ds_write_b32 v63, v203 offset:2176
    ds_write_b32 v55, v204 offset:1408
    ds_write_b32 v55, v205 offset:1664
    ds_write_b32 v55, v206 offset:1920
    s_mov_b32 s54, 0
L_sf:
    ds_read_b32 v54, v21 offset:48
    ds_read_b128 v[112:115], v62 offset:10064
    ds_read_b128 v[116:119], v62 offset:10080
    ds_read_b128 v[120:123], v62 offset:10192
    ds_read_b128 v[124:127], v62 offset:10208
    s_add_u32 s54, s54, 1
    s_cmp_gt_u32 s54, 1048576
    s_waitcnt lgkmcnt(0)
    v_cmp_gt_u32 vcc, 2, v54
    s_cbranch_scc1 L_sf_x
    s_cbranch_vccnz L_sf
L_sf_x:
    v_mfma_f32_16x16x32_bf16 v[208:211], v[64:67], v[112:115], v[208:211]
    v_mfma_f32_16x16x32_bf16 v[208:211], v[68:71], v[116:119], v[208:211]
    v_mfma_f32_16x16x32_bf16 v[208:211], v[72:75], v[120:123], v[208:211]
    v_mfma_f32_16x16x32_bf16 v[208:211], v[76:79], v[124:127], v[208:211]
    v_mfma_f32_16x16x32_bf16 v[212:215], v[80:83], v[112:115], v[212:215]
    v_mfma_f32_16x16x32_bf16 v[212:215], v[84:87], v[116:119], v[212:215]
    v_mfma_f32_16x16x32_bf16 v[212:215], v[88:91], v[120:123], v[212:215]
    v_mfma_f32_16x16x32_bf16 v[212:215], v[92:95], v[124:127], v[212:215]
    s_nop 3
    ds_write_b32 v63, v208 offset:1536
    ds_write_b32 v63, v209 offset:1792
    ds_write_b32 v63, v210 offset:2048
    ds_write_b32 v63, v211 offset:2304
    s_mov_b64 exec, 1
    ds_add_u32 v20, v16 offset:4
    s_mov_b64 exec, -1
    s_nop 0
    ds_read_b32 v54, v20 offset:4
    ds_read_b64 v[24:25], v136
    ds_read_b64 v[26:27], v137
    ds_read_b64 v[28:29], v138
    ds_read_b64 v[30:31], v139
    ds_read_b64 v[32:33], v140
    ds_read_b64 v[34:35], v141
    ds_read_b64 v[36:37], v142
    ds_read_b64 v[38:39], v143
    ds_read_b64 v[40:41], v144
    ds_read_b64 v[42:43], v145
    ds_read_b64 v[44:45], v146
    ds_write_b32 v55, v212 offset:1536
    ds_write_b32 v55, v213 offset:1792
    ds_write_b32 v55, v214 offset:2048
    s_mov_b64 exec, 1
    ds_add_u32 v20, v16 offset:324
    s_mov_b64 exec, -1
    s_waitcnt lgkmcnt(4)
    v_cmp_gt_u32 vcc, 2, v54
    s_nop 0
    s_cbranch_vccnz L_t_retry
L_t_ok:
    ds_read_b32 v22, v11 offset:320
    ds_read_b64 v[152:153], v17 offset:0
    ds_read_b64 v[154:155], v17 offset:8
    ds_read_b64 v[156:157], v17 offset:512
    ds_read_b64 v[158:159], v17 offset:520
    ds_read_b64 v[160:161], v17 offset:1024
    ds_read_b64 v[162:163], v17 offset:1032
    v_add_f32 v24, v24, v25
    v_add_f32 v26, v26, v27
    v_add_f32 v28, v28, v29
    v_add_f32 v30, v30, v31
    v_add_f32 v32, v32, v33
    v_add_f32 v34, v34, v35
    v_add_f32 v36, v36, v37
    v_add_f32 v38, v38, v39
    v_add_f32 v40, v40, v41
    v_add_f32 v42, v42, v43
    v_add_f32_e64 v44, v44, v45
    v_cvt_pk_bf16_f32 v56, v38, v36
    v_cvt_pk_bf16_f32 v57, v34, v32
    v_cvt_pk_bf16_f32 v58, v30, v28
    v_cvt_pk_bf16_f32 v59, v26, v24
    ds_write_b128 v12, v[56:59] offset:0
    v_cvt_pk_bf16_f32 v60, v40, v38
    v_cvt_pk_bf16_f32 v61, v36, v34
    v_cvt_pk_bf16_f32 v62, v32, v30
    v_cvt_pk_bf16_f32 v63, v28, v26
    ds_write_b128 v12, v[60:63] offset:64
    v_cvt_pk_bf16_f32 v64, v42, v40
    v_cvt_pk_bf16_f32 v65, v38, v36
    v_cvt_pk_bf16_f32 v66, v34, v32
    v_cvt_pk_bf16_f32 v67, v30, v28
    ds_write_b128 v12, v[64:67] offset:128
    v_cvt_pk_bf16_f32 v68, v44, v42
    v_cvt_pk_bf16_f32 v69, v40, v38
    v_cvt_pk_bf16_f32 v70, v36, v34
    v_cvt_pk_bf16_f32 v71, v32, v30
    ds_write_b128 v12, v[68:71] offset:192
    ds_read_b128 v[88:91], v13 offset:864
    ds_read_b128 v[92:95], v13 offset:2016
    ds_read_b128 v[96:99], v13 offset:3168
    ds_read_b128 v[100:103], v13 offset:4320
    s_waitcnt lgkmcnt(3)
    v_cmp_gt_u32 vcc, 4, v22
    s_nop 0
    s_cbranch_vccnz L_u_retry
L_u_ok:
    v_mfma_f32_16x16x32_bf16 v[24:27], v[88:91], v[152:155], 0
    ds_read_b64 v[164:165], v17 offset:1536
    s_waitcnt lgkmcnt(3)
    v_mfma_f32_16x16x32_bf16 v[28:31], v[92:95], v[152:155], 0
    ds_read_b64 v[166:167], v17 offset:1544
    s_waitcnt lgkmcnt(3)
    v_mfma_f32_16x16x32_bf16 v[32:35], v[96:99], v[152:155], 0
    ds_read_b64 v[56:57], v17 offset:2048
    s_waitcnt lgkmcnt(3)
    v_mfma_f32_16x16x32_bf16 v[36:39], v[100:103], v[152:155], 0
    ds_read_b64 v[58:59], v17 offset:2056
    v_mfma_f32_16x16x32_bf16 v[28:31], v[88:91], v[156:159], v[28:31]
    ds_read_b64 v[60:61], v17 offset:2560
    v_mfma_f32_16x16x32_bf16 v[32:35], v[92:95], v[156:159], v[32:35]
    ds_read_b64 v[62:63], v17 offset:2568
    v_mfma_f32_16x16x32_bf16 v[36:39], v[96:99], v[156:159], v[36:39]
    ds_read_b64 v[64:65], v17 offset:3072
    v_mfma_f32_16x16x32_bf16 v[40:43], v[100:103], v[156:159], 0
    ds_read_b64 v[66:67], v17 offset:3080
    v_mfma_f32_16x16x32_bf16 v[32:35], v[88:91], v[160:163], v[32:35]
    ds_read_b64 v[68:69], v17 offset:3584
    v_mfma_f32_16x16x32_bf16 v[36:39], v[92:95], v[160:163], v[36:39]
    ds_read_b64 v[70:71], v17 offset:3592
    v_mfma_f32_16x16x32_bf16 v[40:43], v[96:99], v[160:163], v[40:43]
    ds_read_b64 v[168:169], v17 offset:128
    v_mfma_f32_16x16x32_bf16 v[44:47], v[100:103], v[160:163], 0
    ds_read_b64 v[170:171], v17 offset:136
    s_waitcnt lgkmcnt(6)
    v_mfma_f32_16x16x32_bf16 v[36:39], v[88:91], v[164:167], v[36:39]
    ds_read_b128 v[104:107], v13 offset:576
    v_mfma_f32_16x16x32_bf16 v[40:43], v[92:95], v[164:167], v[40:43]
    ds_read_b128 v[108:111], v13 offset:1728
    v_mfma_f32_16x16x32_bf16 v[44:47], v[96:99], v[164:167], v[44:47]
    ds_read_b128 v[112:115], v13 offset:2880
    v_mfma_f32_16x16x32_bf16 v[48:51], v[100:103], v[164:167], 0
    ds_read_b128 v[116:119], v13 offset:4032
    v_mfma_f32_16x16x32_bf16 v[40:43], v[88:91], v[56:59], v[40:43]
    ds_read_b64 v[172:173], v17 offset:640
    v_mfma_f32_16x16x32_bf16 v[44:47], v[92:95], v[56:59], v[44:47]
    ds_read_b64 v[174:175], v17 offset:648
    v_mfma_f32_16x16x32_bf16 v[48:51], v[96:99], v[56:59], v[48:51]
    ds_read_b64 v[176:177], v17 offset:1152
    v_mfma_f32_16x16x32_bf16 v[52:55], v[100:103], v[56:59], 0
    ds_read_b64 v[178:179], v17 offset:1160
    v_mfma_f32_16x16x32_bf16 v[44:47], v[88:91], v[60:63], v[44:47]
    ds_read_b64 v[180:181], v17 offset:1664
    v_mfma_f32_16x16x32_bf16 v[48:51], v[92:95], v[60:63], v[48:51]
    ds_read_b64 v[182:183], v17 offset:1672
    v_mfma_f32_16x16x32_bf16 v[52:55], v[96:99], v[60:63], v[52:55]
    ds_read_b64 v[72:73], v17 offset:2176
    s_waitcnt lgkmcnt(6)
    v_mfma_f32_16x16x32_bf16 v[48:51], v[88:91], v[64:67], v[48:51]
    ds_read_b64 v[74:75], v17 offset:2184
    v_mfma_f32_16x16x32_bf16 v[52:55], v[92:95], v[64:67], v[52:55]
    ds_read_b64 v[76:77], v17 offset:2688
    v_mfma_f32_16x16x32_bf16 v[52:55], v[88:91], v[68:71], v[52:55]
    ds_read_b64 v[78:79], v17 offset:2696
    v_mfma_f32_16x16x32_bf16 v[24:27], v[104:107], v[168:171], v[24:27]
    ds_read_b64 v[80:81], v17 offset:3200
    v_mfma_f32_16x16x32_bf16 v[28:31], v[108:111], v[168:171], v[28:31]
    ds_read_b64 v[82:83], v17 offset:3208
    v_mfma_f32_16x16x32_bf16 v[32:35], v[112:115], v[168:171], v[32:35]
    ds_read_b64 v[84:85], v17 offset:3712
    v_mfma_f32_16x16x32_bf16 v[36:39], v[116:119], v[168:171], v[36:39]
    ds_read_b64 v[86:87], v17 offset:3720
    s_waitcnt lgkmcnt(6)
    v_mfma_f32_16x16x32_bf16 v[28:31], v[104:107], v[172:175], v[28:31]
    ds_read_b64 v[184:185], v17 offset:256
    v_mfma_f32_16x16x32_bf16 v[32:35], v[108:111], v[172:175], v[32:35]
    ds_read_b64 v[186:187], v17 offset:264
    v_mfma_f32_16x16x32_bf16 v[36:39], v[112:115], v[172:175], v[36:39]
    ds_read_b128 v[120:123], v13 offset:288
    v_mfma_f32_16x16x32_bf16 v[40:43], v[116:119], v[172:175], v[40:43]
    ds_read_b128 v[124:127], v13 offset:1440
    v_mfma_f32_16x16x32_bf16 v[32:35], v[104:107], v[176:179], v[32:35]
    ds_read_b128 v[128:131], v13 offset:2592
    v_mfma_f32_16x16x32_bf16 v[36:39], v[108:111], v[176:179], v[36:39]
    ds_read_b128 v[132:135], v13 offset:3744
    v_mfma_f32_16x16x32_bf16 v[40:43], v[112:115], v[176:179], v[40:43]
    ds_read_b64 v[188:189], v17 offset:768
    v_mfma_f32_16x16x32_bf16 v[44:47], v[116:119], v[176:179], v[44:47]
    ds_read_b64 v[190:191], v17 offset:776
    v_mfma_f32_16x16x32_bf16 v[36:39], v[104:107], v[180:183], v[36:39]
    ds_read_b64 v[192:193], v17 offset:1280
    v_mfma_f32_16x16x32_bf16 v[40:43], v[108:111], v[180:183], v[40:43]
    ds_read_b64 v[194:195], v17 offset:1288
    v_mfma_f32_16x16x32_bf16 v[44:47], v[112:115], v[180:183], v[44:47]
    ds_read_b64 v[196:197], v17 offset:1792
    v_mfma_f32_16x16x32_bf16 v[48:51], v[116:119], v[180:183], v[48:51]
    ds_read_b64 v[198:199], v17 offset:1800
    v_mfma_f32_16x16x32_bf16 v[40:43], v[104:107], v[72:75], v[40:43]
    ds_read_b64 v[56:57], v17 offset:2304
    v_mfma_f32_16x16x32_bf16 v[44:47], v[108:111], v[72:75], v[44:47]
    ds_read_b64 v[58:59], v17 offset:2312
    v_mfma_f32_16x16x32_bf16 v[48:51], v[112:115], v[72:75], v[48:51]
    ds_read_b64 v[60:61], v17 offset:2816
    v_mfma_f32_16x16x32_bf16 v[52:55], v[116:119], v[72:75], v[52:55]
    ds_read_b64 v[62:63], v17 offset:2824
    s_waitcnt lgkmcnt(6)
    v_mfma_f32_16x16x32_bf16 v[44:47], v[104:107], v[76:79], v[44:47]
    ds_read_b64 v[64:65], v17 offset:3328
    v_mfma_f32_16x16x32_bf16 v[48:51], v[108:111], v[76:79], v[48:51]
    ds_read_b64 v[66:67], v17 offset:3336
    v_mfma_f32_16x16x32_bf16 v[52:55], v[112:115], v[76:79], v[52:55]
    ds_read_b64 v[68:69], v17 offset:3840
    v_mfma_f32_16x16x32_bf16 v[48:51], v[104:107], v[80:83], v[48:51]
    ds_read_b64 v[70:71], v17 offset:3848
    v_mfma_f32_16x16x32_bf16 v[52:55], v[108:111], v[80:83], v[52:55]
    ds_read_b64 v[200:201], v17 offset:384
    v_mfma_f32_16x16x32_bf16 v[52:55], v[104:107], v[84:87], v[52:55]
    ds_read_b64 v[202:203], v17 offset:392
    v_mfma_f32_16x16x32_bf16 v[24:27], v[120:123], v[184:187], v[24:27]
    ds_read_b128 v[136:139], v13 offset:0
    v_mfma_f32_16x16x32_bf16 v[28:31], v[124:127], v[184:187], v[28:31]
    ds_read_b128 v[140:143], v13 offset:1152
    v_mfma_f32_16x16x32_bf16 v[32:35], v[128:131], v[184:187], v[32:35]
    ds_read_b64 v[204:205], v17 offset:896
    v_mfma_f32_16x16x32_bf16 v[36:39], v[132:135], v[184:187], v[36:39]
    ds_read_b64 v[206:207], v17 offset:904
    v_mfma_f32_16x16x32_bf16 v[28:31], v[120:123], v[188:191], v[28:31]
    ds_read_b128 v[144:147], v13 offset:2304
    v_mfma_f32_16x16x32_bf16 v[32:35], v[124:127], v[188:191], v[32:35]
    ds_read_b64 v[208:209], v17 offset:1408
    v_mfma_f32_16x16x32_bf16 v[36:39], v[128:131], v[188:191], v[36:39]
    ds_read_b64 v[210:211], v17 offset:1416
    v_mfma_f32_16x16x32_bf16 v[40:43], v[132:135], v[188:191], v[40:43]
    ds_read_b128 v[148:151], v13 offset:3456
    v_mfma_f32_16x16x32_bf16 v[32:35], v[120:123], v[192:195], v[32:35]
    ds_read_b64 v[212:213], v17 offset:1920
    v_mfma_f32_16x16x32_bf16 v[36:39], v[124:127], v[192:195], v[36:39]
    ds_read_b64 v[214:215], v17 offset:1928
    v_mfma_f32_16x16x32_bf16 v[40:43], v[128:131], v[192:195], v[40:43]
    ds_read_b64 v[72:73], v17 offset:2432
    v_mfma_f32_16x16x32_bf16 v[44:47], v[132:135], v[192:195], v[44:47]
    ds_read_b64 v[74:75], v17 offset:2440
    s_waitcnt lgkmcnt(6)
    v_mfma_f32_16x16x32_bf16 v[36:39], v[120:123], v[196:199], v[36:39]
    ds_read_b64 v[76:77], v17 offset:2944
    v_mfma_f32_16x16x32_bf16 v[40:43], v[124:127], v[196:199], v[40:43]
    ds_read_b64 v[78:79], v17 offset:2952
    v_mfma_f32_16x16x32_bf16 v[44:47], v[128:131], v[196:199], v[44:47]
    ds_read_b64 v[80:81], v17 offset:3456
    v_mfma_f32_16x16x32_bf16 v[48:51], v[132:135], v[196:199], v[48:51]
    ds_read_b64 v[82:83], v17 offset:3464
    v_mfma_f32_16x16x32_bf16 v[40:43], v[120:123], v[56:59], v[40:43]
    ds_read_b64 v[84:85], v17 offset:3968
    v_mfma_f32_16x16x32_bf16 v[44:47], v[124:127], v[56:59], v[44:47]
    ds_read_b64 v[86:87], v17 offset:3976
    v_mfma_f32_16x16x32_bf16 v[48:51], v[128:131], v[56:59], v[48:51]
    v_mfma_f32_16x16x32_bf16 v[52:55], v[132:135], v[56:59], v[52:55]
    v_mfma_f32_16x16x32_bf16 v[44:47], v[120:123], v[60:63], v[44:47]
    v_mfma_f32_16x16x32_bf16 v[48:51], v[124:127], v[60:63], v[48:51]
    v_mfma_f32_16x16x32_bf16 v[52:55], v[128:131], v[60:63], v[52:55]
    v_mfma_f32_16x16x32_bf16 v[48:51], v[120:123], v[64:67], v[48:51]
    v_mfma_f32_16x16x32_bf16 v[52:55], v[124:127], v[64:67], v[52:55]
    v_mfma_f32_16x16x32_bf16 v[52:55], v[120:123], v[68:71], v[52:55]
    v_mfma_f32_16x16x32_bf16 v[24:27], v[136:139], v[200:203], v[24:27]
    v_mfma_f32_16x16x32_bf16 v[28:31], v[140:143], v[200:203], v[28:31]
    v_mfma_f32_16x16x32_bf16 v[28:31], v[136:139], v[204:207], v[28:31]
    v_mfma_f32_16x16x32_bf16 v[32:35], v[144:147], v[200:203], v[32:35]
    v_mfma_f32_16x16x32_bf16 v[32:35], v[140:143], v[204:207], v[32:35]
    s_waitcnt lgkmcnt(0)
    v_mfma_f32_16x16x32_bf16 v[32:35], v[136:139], v[208:211], v[32:35]
    v_mfma_f32_16x16x32_bf16 v[36:39], v[148:151], v[200:203], v[36:39]
    v_mfma_f32_16x16x32_bf16 v[36:39], v[144:147], v[204:207], v[36:39]
    v_mfma_f32_16x16x32_bf16 v[36:39], v[140:143], v[208:211], v[36:39]
    ds_write_b128 v15, v[24:27] offset:0
    v_mfma_f32_16x16x32_bf16 v[36:39], v[136:139], v[212:215], v[36:39]
    v_mfma_f32_16x16x32_bf16 v[40:43], v[148:151], v[204:207], v[40:43]
    ds_write_b128 v15, v[28:31] offset:1024
    v_mfma_f32_16x16x32_bf16 v[40:43], v[144:147], v[208:211], v[40:43]
    v_mfma_f32_16x16x32_bf16 v[40:43], v[140:143], v[212:215], v[40:43]
    v_mfma_f32_16x16x32_bf16 v[40:43], v[136:139], v[72:75], v[40:43]
    ds_write_b128 v15, v[32:35] offset:2048
    v_mfma_f32_16x16x32_bf16 v[44:47], v[148:151], v[208:211], v[44:47]
    v_mfma_f32_16x16x32_bf16 v[44:47], v[144:147], v[212:215], v[44:47]
    v_mfma_f32_16x16x32_bf16 v[44:47], v[140:143], v[72:75], v[44:47]
    v_mfma_f32_16x16x32_bf16 v[44:47], v[136:139], v[76:79], v[44:47]
    ds_write_b128 v15, v[36:39] offset:3072
    v_mfma_f32_16x16x32_bf16 v[48:51], v[148:151], v[212:215], v[48:51]
    v_mfma_f32_16x16x32_bf16 v[48:51], v[144:147], v[72:75], v[48:51]
    s_waitcnt lgkmcnt(0)
    s_barrier
    ds_read_b128 v[88:91], v13 offset:5472
    v_mfma_f32_16x16x32_bf16 v[48:51], v[140:143], v[76:79], v[48:51]
    ds_read_b128 v[104:107], v13 offset:5184
    v_mfma_f32_16x16x32_bf16 v[48:51], v[136:139], v[80:83], v[48:51]
    ds_read_b128 v[120:123], v13 offset:4896
    v_mfma_f32_16x16x32_bf16 v[52:55], v[148:151], v[72:75], v[52:55]
    ds_read_b128 v[216:219], v13 offset:4608
    v_mfma_f32_16x16x32_bf16 v[52:55], v[144:147], v[76:79], v[52:55]
    ds_read_b128 v[92:95], v13 offset:6624
    v_mfma_f32_16x16x32_bf16 v[52:55], v[140:143], v[80:83], v[52:55]
    ds_read_b128 v[108:111], v13 offset:6336
    v_mfma_f32_16x16x32_bf16 v[52:55], v[136:139], v[84:87], v[52:55]
    ds_read_b128 v[124:127], v13 offset:6048
    s_waitcnt lgkmcnt(6)
    v_mfma_f32_16x16x32_bf16 v[40:43], v[88:91], v[152:155], v[40:43]
    ds_read_b128 v[220:223], v13 offset:5760
    s_waitcnt lgkmcnt(6)
    v_mfma_f32_16x16x32_bf16 v[40:43], v[104:107], v[168:171], v[40:43]
    ds_read_b128 v[96:99], v13 offset:7776
    s_waitcnt lgkmcnt(6)
    v_mfma_f32_16x16x32_bf16 v[40:43], v[120:123], v[184:187], v[40:43]
    ds_read_b128 v[112:115], v13 offset:7488
    s_waitcnt lgkmcnt(6)
    v_mfma_f32_16x16x32_bf16 v[40:43], v[216:219], v[200:203], v[40:43]
    ds_read_b128 v[128:131], v13 offset:7200
    v_mfma_f32_16x16x32_bf16 v[44:47], v[88:91], v[156:159], v[44:47]
    ds_read_b128 v[224:227], v13 offset:6912
    v_mfma_f32_16x16x32_bf16 v[44:47], v[104:107], v[172:175], v[44:47]
    ds_read_b128 v[100:103], v13 offset:8928
    v_mfma_f32_16x16x32_bf16 v[44:47], v[120:123], v[188:191], v[44:47]
    ds_read_b128 v[116:119], v13 offset:8640
    v_mfma_f32_16x16x32_bf16 v[44:47], v[216:219], v[204:207], v[44:47]
    ds_read_b128 v[132:135], v13 offset:8352
    s_waitcnt lgkmcnt(6)
    v_mfma_f32_16x16x32_bf16 v[44:47], v[92:95], v[152:155], v[44:47]
    ds_read_b128 v[228:231], v13 offset:8064
    v_mfma_f32_16x16x32_bf16 v[44:47], v[108:111], v[168:171], v[44:47]
    v_mfma_f32_16x16x32_bf16 v[44:47], v[124:127], v[184:187], v[44:47]
    v_mfma_f32_16x16x32_bf16 v[44:47], v[220:223], v[200:203], v[44:47]
    ds_write_b128 v15, v[40:43] offset:4096
    v_mfma_f32_16x16x32_bf16 v[48:51], v[88:91], v[160:163], v[48:51]
    v_mfma_f32_16x16x32_bf16 v[48:51], v[104:107], v[176:179], v[48:51]
    v_mfma_f32_16x16x32_bf16 v[48:51], v[120:123], v[192:195], v[48:51]
    v_mfma_f32_16x16x32_bf16 v[48:51], v[216:219], v[208:211], v[48:51]
    v_mfma_f32_16x16x32_bf16 v[48:51], v[92:95], v[156:159], v[48:51]
    v_mfma_f32_16x16x32_bf16 v[48:51], v[108:111], v[172:175], v[48:51]
    v_mfma_f32_16x16x32_bf16 v[48:51], v[124:127], v[188:191], v[48:51]
    v_mfma_f32_16x16x32_bf16 v[48:51], v[220:223], v[204:207], v[48:51]
    ds_write_b128 v15, v[44:47] offset:5120
    v_mfma_f32_16x16x32_bf16 v[48:51], v[96:99], v[152:155], v[48:51]
    s_waitcnt lgkmcnt(1)
    v_mfma_f32_16x16x32_bf16 v[48:51], v[112:115], v[168:171], v[48:51]
    v_mfma_f32_16x16x32_bf16 v[48:51], v[128:131], v[184:187], v[48:51]
    v_mfma_f32_16x16x32_bf16 v[48:51], v[224:227], v[200:203], v[48:51]
    v_mfma_f32_16x16x32_bf16 v[52:55], v[88:91], v[164:167], v[52:55]
    v_mfma_f32_16x16x32_bf16 v[52:55], v[104:107], v[180:183], v[52:55]
    v_mfma_f32_16x16x32_bf16 v[52:55], v[120:123], v[196:199], v[52:55]
    v_mfma_f32_16x16x32_bf16 v[52:55], v[216:219], v[212:215], v[52:55]
    v_mfma_f32_16x16x32_bf16 v[52:55], v[92:95], v[160:163], v[52:55]
    v_mfma_f32_16x16x32_bf16 v[52:55], v[108:111], v[176:179], v[52:55]
    v_mfma_f32_16x16x32_bf16 v[52:55], v[124:127], v[192:195], v[52:55]
    v_mfma_f32_16x16x32_bf16 v[52:55], v[220:223], v[208:211], v[52:55]
    ds_write_b128 v15, v[48:51] offset:6144
    v_mfma_f32_16x16x32_bf16 v[52:55], v[96:99], v[156:159], v[52:55]
    v_mfma_f32_16x16x32_bf16 v[52:55], v[112:115], v[172:175], v[52:55]
    v_mfma_f32_16x16x32_bf16 v[52:55], v[128:131], v[188:191], v[52:55]
    v_mfma_f32_16x16x32_bf16 v[52:55], v[224:227], v[204:207], v[52:55]
    v_mfma_f32_16x16x32_bf16 v[52:55], v[100:103], v[152:155], v[52:55]
    v_mfma_f32_16x16x32_bf16 v[52:55], v[116:119], v[168:171], v[52:55]
    v_mfma_f32_16x16x32_bf16 v[52:55], v[132:135], v[184:187], v[52:55]
    v_mfma_f32_16x16x32_bf16 v[52:55], v[228:231], v[200:203], v[52:55]
    s_nop 7
    ds_write_b128 v15, v[52:55] offset:7168
    s_waitcnt lgkmcnt(0)
    s_barrier
    s_branch L_fin
L_C_spare:
    s_mov_b32 s46, -1
    s_mov_b32 s47, 0xffffff
    v_lshrrev_b32 v20, 3, v0
    v_and_b32 v21, 7, v0
    v_mul_u32_u24 v22, 3584, v20
    v_lshl_add_u32 v22, v21, 4, v22
    s_lshl_b32 s55, s41, 7
    v_add_u32 v22, s55, v22
    s_mul_i32 s55, s41, 57344
    v_lshl_add_u32 v23, v0, 4, s55
    v_mul_u32_u24 v2, 272, v20
    v_lshl_add_u32 v2, v21, 4, v2
    v_add_u32 v3, 60928, v2
    v_and_b32 v20, 32, v1
    v_lshrrev_b32 v20, 1, v20
    v_bfe_u32 v21, v1, 4, 1
    v_lshl_add_u32 v20, v21, 2, v20
    v_bfe_u32 v21, v1, 2, 1
    v_and_b32 v4, 8, v1
    v_add3_u32 v20, v20, v21, v4
    v_and_b32 v5, 3, v1
    v_lshlrev_b32 v5, 3, v5
    s_lshl_b32 s55, s42, 5
    v_mul_u32_u24 v6, 272, v20
    v_add3_u32 v6, v6, v5, s55
    v_add_u32 v7, 60928, v6
    s_mul_i32 s55, s42, 224
    v_mul_u32_u24 v8, 912, v20
    v_add3_u32 v8, v8, v5, s55
    s_waitcnt vmcnt(0)
    s_mov_b32 s54, 0
L_sf0:
    ds_read_b32 v9, v11 offset:16
    ds_read_b32 v19, v11 offset:28
    s_add_u32 s54, s54, 1
    s_cmp_gt_u32 s54, 1048576
    s_waitcnt lgkmcnt(0)
    v_cmp_gt_u32 vcc, 4, v9
    s_cbranch_scc1 L_sf0_x
    s_cbranch_vccnz L_sf0
L_sf0_x:
    v_readfirstlane_b32 s43, v19
    s_getreg_b32 s51, hwreg(HW_REG_XCC_ID, 2, 1)
    s_cmp_eq_u32 s38, 7
    s_cbranch_scc1 L_idle
    global_load_dwordx4 v[136:139], v23, s[30:31]
    s_add_u32 s30, s30, 4096
    s_addc_u32 s31, s31, 0
    global_load_dwordx4 v[140:143], v23, s[30:31]
    s_add_u32 s30, s30, 4096
    s_addc_u32 s31, s31, 0
    global_load_dwordx4 v[144:147], v23, s[30:31]
    s_add_u32 s30, s30, 4096
    s_addc_u32 s31, s31, 0
    global_load_dwordx4 v[148:151], v23, s[30:31]
    s_add_u32 s30, s30, 4096
    s_addc_u32 s31, s31, 0
    global_load_dwordx4 v[152:155], v23, s[30:31]
    s_add_u32 s30, s30, 4096
    s_addc_u32 s31, s31, 0
    global_load_dwordx4 v[156:159], v23, s[30:31]
    s_add_u32 s30, s30, 4096
    s_addc_u32 s31, s31, 0
    global_load_dwordx4 v[160:163], v23, s[30:31]
    s_add_u32 s30, s30, 4096
    s_addc_u32 s31, s31, 0
    global_load_dwordx4 v[164:167], v23, s[30:31]
    s_add_u32 s30, s30, 4096
    s_addc_u32 s31, s31, 0
    global_load_dwordx4 v[168:171], v23, s[30:31]
    s_add_u32 s30, s30, 4096
    s_addc_u32 s31, s31, 0
    global_load_dwordx4 v[172:175], v23, s[30:31]
    s_add_u32 s30, s30, 4096
    s_addc_u32 s31, s31, 0
    global_load_dwordx4 v[176:179], v23, s[30:31]
    s_add_u32 s30, s30, 4096
    s_addc_u32 s31, s31, 0
    global_load_dwordx4 v[180:183], v23, s[30:31]
    s_add_u32 s30, s30, 4096
    s_addc_u32 s31, s31, 0
    global_load_dwordx4 v[184:187], v23, s[30:31]
    s_add_u32 s30, s30, 4096
    s_addc_u32 s31, s31, 0
    global_load_dwordx4 v[188:191], v23, s[30:31]
    global_load_dwordx4 v[24:27], v22, s[26:27]
    s_add_u32 s26, s26, 114688
    s_addc_u32 s27, s27, 0
    s_mov_b32 s55, 76695845
    v_add_u32 v9, 0, v0
    v_mul_hi_u32 v10, v9, s55
    v_add_lshl_u32 v9, v9, v10, 4
    s_waitcnt vmcnt(14)
    ds_write_b128 v9, v[136:139] offset:1408
    global_load_dwordx4 v[32:35], v22, s[28:29]
    s_add_u32 s28, s28, 114688
    s_addc_u32 s29, s29, 0
    v_add_u32 v9, 256, v0
    v_mul_hi_u32 v10, v9, s55
    v_add_lshl_u32 v9, v9, v10, 4
    s_waitcnt vmcnt(14)
    ds_write_b128 v9, v[140:143] offset:1408
    global_load_dwordx4 v[28:31], v22, s[26:27]
    s_add_u32 s26, s26, 114688
    s_addc_u32 s27, s27, 0
    v_add_u32 v9, 512, v0
    v_mul_hi_u32 v10, v9, s55
    v_add_lshl_u32 v9, v9, v10, 4
    s_waitcnt vmcnt(14)
    ds_write_b128 v9, v[144:147] offset:1408
    global_load_dwordx4 v[36:39], v22, s[28:29]
    s_add_u32 s28, s28, 114688
    s_addc_u32 s29, s29, 0
    v_add_u32 v9, 768, v0
    v_mul_hi_u32 v10, v9, s55
    v_add_lshl_u32 v9, v9, v10, 4
    s_waitcnt vmcnt(14)
    ds_write_b128 v9, v[148:151] offset:1408
    global_load_dwordx4 v[40:43], v22, s[26:27]
    s_add_u32 s26, s26, 114688
    s_addc_u32 s27, s27, 0
    v_add_u32 v9, 1024, v0
    v_mul_hi_u32 v10, v9, s55
    v_add_lshl_u32 v9, v9, v10, 4
    s_waitcnt vmcnt(14)
    ds_write_b128 v9, v[152:155] offset:1408
    global_load_dwordx4 v[48:51], v22, s[28:29]
    s_add_u32 s28, s28, 114688
    s_addc_u32 s29, s29, 0
    v_add_u32 v9, 1280, v0
    v_mul_hi_u32 v10, v9, s55
    v_add_lshl_u32 v9, v9, v10, 4
    s_waitcnt vmcnt(14)
    ds_write_b128 v9, v[156:159] offset:1408
    global_load_dwordx4 v[44:47], v22, s[26:27]
    s_add_u32 s26, s26, 114688
    s_addc_u32 s27, s27, 0
    v_add_u32 v9, 1536, v0
    v_mul_hi_u32 v10, v9, s55
    v_add_lshl_u32 v9, v9, v10, 4
    s_waitcnt vmcnt(14)
    ds_write_b128 v9, v[160:163] offset:1408
    global_load_dwordx4 v[52:55], v22, s[28:29]
    s_add_u32 s28, s28, 114688
    s_addc_u32 s29, s29, 0
    v_add_u32 v9, 1792, v0
    v_mul_hi_u32 v10, v9, s55
    v_add_lshl_u32 v9, v9, v10, 4
    s_waitcnt vmcnt(14)
    ds_write_b128 v9, v[164:167] offset:1408
    global_load_dwordx4 v[56:59], v22, s[26:27]
    s_add_u32 s26, s26, 114688
    s_addc_u32 s27, s27, 0
    v_add_u32 v9, 2048, v0
    v_mul_hi_u32 v10, v9, s55
    v_add_lshl_u32 v9, v9, v10, 4
    s_waitcnt vmcnt(14)
    ds_write_b128 v9, v[168:171] offset:1408
    global_load_dwordx4 v[64:67], v22, s[28:29]
    s_add_u32 s28, s28, 114688
    s_addc_u32 s29, s29, 0
    v_add_u32 v9, 2304, v0
    v_mul_hi_u32 v10, v9, s55
    v_add_lshl_u32 v9, v9, v10, 4
    s_waitcnt vmcnt(14)
    ds_write_b128 v9, v[172:175] offset:1408
    global_load_dwordx4 v[60:63], v22, s[26:27]
    s_add_u32 s26, s26, 114688
    s_addc_u32 s27, s27, 0
    v_add_u32 v9, 2560, v0
    v_mul_hi_u32 v10, v9, s55
    v_add_lshl_u32 v9, v9, v10, 4
    s_waitcnt vmcnt(14)
    ds_write_b128 v9, v[176:179] offset:1408
    global_load_dwordx4 v[68:71], v22, s[28:29]
    s_add_u32 s28, s28, 114688
    s_addc_u32 s29, s29, 0
    v_add_u32 v9, 2816, v0
    v_mul_hi_u32 v10, v9, s55
    v_add_lshl_u32 v9, v9, v10, 4
    s_waitcnt vmcnt(14)
    ds_write_b128 v9, v[180:183] offset:1408
    global_load_dwordx4 v[72:75], v22, s[26:27]
    s_add_u32 s26, s26, 114688
    s_addc_u32 s27, s27, 0
    v_add_u32 v9, 3072, v0
    v_mul_hi_u32 v10, v9, s55
    v_add_lshl_u32 v9, v9, v10, 4
    s_waitcnt vmcnt(14)
    ds_write_b128 v9, v[184:187] offset:1408
    global_load_dwordx4 v[80:83], v22, s[28:29]
    s_add_u32 s28, s28, 114688
    s_addc_u32 s29, s29, 0
    v_add_u32 v9, 3328, v0
    v_mul_hi_u32 v10, v9, s55
    v_add_lshl_u32 v9, v9, v10, 4
    s_waitcnt vmcnt(14)
    ds_write_b128 v9, v[188:191] offset:1408
    global_load_dwordx4 v[76:79], v22, s[26:27]
    s_add_u32 s26, s26, 114688
    s_addc_u32 s27, s27, 0
    s_mov_b64 exec, 1
    ds_add_u32 v11, v16 offset:20
    s_mov_b64 exec, -1
    s_waitcnt vmcnt(14)
    ds_write_b128 v3, v[24:27] offset:1408
    global_load_dwordx4 v[84:87], v22, s[28:29]
    s_add_u32 s28, s28, 114688
    s_addc_u32 s29, s29, 0
    s_waitcnt vmcnt(14)
    ds_write_b128 v3, v[32:35] offset:1536
    global_load_dwordx4 v[88:91], v22, s[26:27]
    s_add_u32 s26, s26, 114688
    s_addc_u32 s27, s27, 0
    s_waitcnt vmcnt(14)
    ds_write_b128 v3, v[28:31] offset:10112
    global_load_dwordx4 v[96:99], v22, s[28:29]
    s_add_u32 s28, s28, 114688
    s_addc_u32 s29, s29, 0
    s_waitcnt vmcnt(14)
    ds_write_b128 v3, v[36:39] offset:10240
    global_load_dwordx4 v[92:95], v22, s[26:27]
    s_add_u32 s26, s26, 114688
    s_addc_u32 s27, s27, 0
    s_mov_b32 s54, 0
L_sf1:
    ds_read_b32 v9, v11 offset:20
    s_add_u32 s54, s54, 1
    s_cmp_gt_u32 s54, 1048576
    s_waitcnt lgkmcnt(0)
    v_cmp_gt_u32 vcc, 4, v9
    s_cbranch_scc1 L_sf1_x
    s_cbranch_vccnz L_sf1
L_sf1_x:
    ds_read_b64_tr_b16 v[136:137], v8 offset:1408
    ds_read_b64_tr_b16 v[138:139], v8 offset:3232
    ds_read_b64_tr_b16 v[140:141], v8 offset:30592
    ds_read_b64_tr_b16 v[142:143], v8 offset:32416
    ds_read_b64_tr_b16 v[144:145], v8 offset:1440
    ds_read_b64_tr_b16 v[146:147], v8 offset:3264
    ds_read_b64_tr_b16 v[148:149], v8 offset:30624
    ds_read_b64_tr_b16 v[150:151], v8 offset:32448
    ds_read_b64_tr_b16 v[152:153], v8 offset:1472
    ds_read_b64_tr_b16 v[154:155], v8 offset:3296
    ds_read_b64_tr_b16 v[156:157], v8 offset:30656
    ds_read_b64_tr_b16 v[158:159], v8 offset:32480
    ds_read_b64_tr_b16 v[160:161], v8 offset:1504
    ds_read_b64_tr_b16 v[162:163], v8 offset:3328
    ds_read_b64_tr_b16 v[164:165], v8 offset:30688
    ds_read_b64_tr_b16 v[166:167], v8 offset:32512
    ds_read_b64_tr_b16 v[168:169], v8 offset:1536
    ds_read_b64_tr_b16 v[170:171], v8 offset:3360
    ds_read_b64_tr_b16 v[172:173], v8 offset:30720
    ds_read_b64_tr_b16 v[174:175], v8 offset:32544
    ds_read_b64_tr_b16 v[176:177], v8 offset:1568
    ds_read_b64_tr_b16 v[178:179], v8 offset:3392
    ds_read_b64_tr_b16 v[180:181], v8 offset:30752
    ds_read_b64_tr_b16 v[182:183], v8 offset:32576
    ds_read_b64_tr_b16 v[184:185], v8 offset:1600
    ds_read_b64_tr_b16 v[186:187], v8 offset:3424
    ds_read_b64_tr_b16 v[188:189], v8 offset:30784
    ds_read_b64_tr_b16 v[190:191], v8 offset:32608
    s_waitcnt vmcnt(14)
    ds_write_b128 v3, v[40:43] offset:18816
    global_load_dwordx4 v[100:103], v22, s[28:29]
    s_add_u32 s28, s28, 114688
    s_addc_u32 s29, s29, 0
    s_waitcnt vmcnt(14)
    ds_write_b128 v3, v[48:51] offset:18944
    global_load_dwordx4 v[104:107], v22, s[26:27]
    s_add_u32 s26, s26, 114688
    s_addc_u32 s27, s27, 0
    s_waitcnt vmcnt(14)
    ds_write_b128 v3, v[44:47] offset:27520
    global_load_dwordx4 v[112:115], v22, s[28:29]
    s_add_u32 s28, s28, 114688
    s_addc_u32 s29, s29, 0
    s_waitcnt vmcnt(14)
    ds_write_b128 v3, v[52:55] offset:27648
    global_load_dwordx4 v[108:111], v22, s[26:27]
    s_add_u32 s26, s26, 114688
    s_addc_u32 s27, s27, 0
    s_waitcnt vmcnt(14)
    ds_write_b128 v3, v[56:59] offset:36224
    global_load_dwordx4 v[116:119], v22, s[28:29]
    s_add_u32 s28, s28, 114688
    s_addc_u32 s29, s29, 0
    s_waitcnt vmcnt(14)
    ds_write_b128 v3, v[64:67] offset:36352
    global_load_dwordx4 v[120:123], v22, s[26:27]
    s_add_u32 s26, s26, 114688
    s_addc_u32 s27, s27, 0
    s_waitcnt vmcnt(14)
    ds_write_b128 v3, v[60:63] offset:44928
    global_load_dwordx4 v[128:131], v22, s[28:29]
    s_add_u32 s28, s28, 114688
    s_addc_u32 s29, s29, 0
    s_waitcnt vmcnt(14)
    ds_write_b128 v3, v[68:71] offset:45056
    global_load_dwordx4 v[124:127], v22, s[26:27]
    s_waitcnt vmcnt(14)
    ds_write_b128 v3, v[72:75] offset:53632
    global_load_dwordx4 v[132:135], v22, s[28:29]
    s_waitcnt vmcnt(14)
    ds_write_b128 v3, v[80:83] offset:53760
    s_mov_b64 exec, 1
    ds_add_u32 v11, v16 offset:20
    s_mov_b64 exec, -1
    s_mov_b32 s54, 0
L_sf2:
    ds_read_b32 v9, v11 offset:20
    s_add_u32 s54, s54, 1
    s_cmp_gt_u32 s54, 1048576
    s_waitcnt lgkmcnt(0)
    v_cmp_gt_u32 vcc, 8, v9
    s_cbranch_scc1 L_sf2_x
    s_cbranch_vccnz L_sf2
L_sf2_x:
    s_nop 0
    ds_read_b64_tr_b16 v[24:25], v7 offset:1408
    ds_read_b64_tr_b16 v[26:27], v7 offset:1952
    ds_read_b64_tr_b16 v[32:33], v7 offset:1536
    ds_read_b64_tr_b16 v[34:35], v7 offset:2080
    ds_read_b64_tr_b16 v[28:29], v7 offset:10112
    ds_read_b64_tr_b16 v[30:31], v7 offset:10656
    ds_read_b64_tr_b16 v[36:37], v7 offset:10240
    ds_read_b64_tr_b16 v[38:39], v7 offset:10784
    ds_read_b64_tr_b16 v[40:41], v7 offset:18816
    ds_read_b64_tr_b16 v[42:43], v7 offset:19360
    ds_read_b64_tr_b16 v[48:49], v7 offset:18944
    ds_read_b64_tr_b16 v[50:51], v7 offset:19488
    ds_read_b64_tr_b16 v[44:45], v7 offset:27520
    ds_read_b64_tr_b16 v[46:47], v7 offset:28064
    ds_read_b64_tr_b16 v[52:53], v7 offset:27648
    ds_read_b64_tr_b16 v[54:55], v7 offset:28192
    ds_read_b64_tr_b16 v[56:57], v7 offset:36224
    ds_read_b64_tr_b16 v[58:59], v7 offset:36768
    ds_read_b64_tr_b16 v[64:65], v7 offset:36352
    ds_read_b64_tr_b16 v[66:67], v7 offset:36896
    ds_read_b64_tr_b16 v[60:61], v7 offset:44928
    ds_read_b64_tr_b16 v[62:63], v7 offset:45472
    ds_read_b64_tr_b16 v[68:69], v7 offset:45056
    ds_read_b64_tr_b16 v[70:71], v7 offset:45600
    ds_read_b64_tr_b16 v[72:73], v7 offset:53632
    ds_read_b64_tr_b16 v[74:75], v7 offset:54176
    ds_read_b64_tr_b16 v[80:81], v7 offset:53760
    ds_read_b64_tr_b16 v[82:83], v7 offset:54304
    s_waitcnt vmcnt(13)
    ds_write_b128 v2, v[76:79] offset:1408
    s_waitcnt vmcnt(12)
    ds_write_b128 v2, v[84:87] offset:1536
    s_waitcnt vmcnt(11)
    ds_write_b128 v2, v[88:91] offset:10112
    s_waitcnt vmcnt(10)
    ds_write_b128 v2, v[96:99] offset:10240
    s_waitcnt vmcnt(9)
    ds_write_b128 v2, v[92:95] offset:18816
    s_waitcnt vmcnt(8)
    ds_write_b128 v2, v[100:103] offset:18944
    s_waitcnt vmcnt(7)
    ds_write_b128 v2, v[104:107] offset:27520
    s_waitcnt vmcnt(6)
    ds_write_b128 v2, v[112:115] offset:27648
    s_waitcnt vmcnt(5)
    ds_write_b128 v2, v[108:111] offset:36224
    s_waitcnt vmcnt(4)
    ds_write_b128 v2, v[116:119] offset:36352
    s_waitcnt vmcnt(3)
    ds_write_b128 v2, v[120:123] offset:44928
    s_waitcnt vmcnt(2)
    ds_write_b128 v2, v[128:131] offset:45056
    s_waitcnt vmcnt(1)
    ds_write_b128 v2, v[124:127] offset:53632
    s_waitcnt vmcnt(0)
    ds_write_b128 v2, v[132:135] offset:53760
    s_mov_b64 exec, 1
    ds_add_u32 v11, v16 offset:20
    s_mov_b64 exec, -1
    s_lshr_b32 s55, s41, 1
    s_lshl_b32 s55, s55, 14
    s_and_b32 s56, s41, 1
    s_lshl_b32 s56, s56, 12
    s_add_u32 s55, s55, s56
    s_mul_i32 s56, s42, 896
    s_add_u32 s55, s55, s56
    s_add_u32 s55, s55, 2228224
    v_lshl_add_u32 v23, v1, 3, s55
    v_add_u32 v21, 0x2000, v23
    v_add_u32 v9, s55, v18
    v_add_u32 v10, 0x2000, v9
    v_not_b32 v193, v19
    v_not_b32 v195, v19
    v_mov_b32 v2, 2490368
    s_mov_b64 exec, s[46:47]
    global_store_dwordx4 v9, v[192:195], s[36:37] sc1
    global_store_dwordx4 v10, v[192:195], s[36:37] sc1
    s_mov_b64 exec, 1
    global_load_dwordx2 v[196:197], v2, s[36:37] sc1
    s_mov_b64 exec, -1
    v_and_b32 v2, 1, v1
    v_mul_u32_u24 v17, 0xaaaa, v2
    v_add_u32 v17, 0x4444, v17
    v_and_b32 v3, 0x30, v1
    v_lshlrev_b32 v3, 1, v3
    v_lshl_add_u32 v20, v2, 4, v3
    v_add_u32 v2, 64, v20
    v_mov_b32 v3, 192
    v_bfe_u32 v4, v1, 2, 2
    v_cmp_eq_u32 vcc, 0, v4
    s_nop 1
    v_cndmask_b32 v12, v3, v2, vcc
    v_cmp_eq_u32 vcc, 1, v4
    s_nop 1
    v_cndmask_b32 v13, v3, v2, vcc
    v_cmp_eq_u32 vcc, 2, v4
    s_nop 1
    v_cndmask_b32 v14, v3, v2, vcc
    v_cmp_eq_u32 vcc, 3, v4
    s_nop 1
    v_cndmask_b32 v15, v3, v2, vcc
    s_lshl_b32 s55, s42, 5
    s_add_u32 s55, s55, 64
    v_lshl_add_u32 v22, v1, 1, s55
    v_mov_b32 v240, 0
    v_mov_b32 v241, 0
    v_mov_b32 v242, 0
    v_mov_b32 v243, 0
    v_mov_b32 v244, 0
    v_mov_b32 v245, 0
    v_mov_b32 v246, 0
    v_mov_b32 v247, 0
    v_mov_b32 v248, 0
    v_mov_b32 v249, 0
    v_mov_b32 v250, 0
    v_mov_b32 v251, 0
    v_mov_b32 v252, 0
    v_mov_b32 v253, 0
    v_mov_b32 v254, 0
    v_mov_b32 v255, 0
    s_mov_b32 s54, 0
L_sf3:
    ds_read_b32 v9, v11 offset:20
    s_add_u32 s54, s54, 1
    s_cmp_gt_u32 s54, 1048576
    s_waitcnt lgkmcnt(0)
    v_cmp_gt_u32 vcc, 12, v9
    s_cbranch_scc1 L_sf3_x
    s_cbranch_vccnz L_sf3
L_sf3_x:
    ds_read_b64_tr_b16 v[76:77], v6 offset:1408
    ds_read_b64_tr_b16 v[78:79], v6 offset:1952
    ds_read_b64_tr_b16 v[84:85], v6 offset:1536
    ds_read_b64_tr_b16 v[86:87], v6 offset:2080
    ds_read_b64_tr_b16 v[88:89], v6 offset:10112
    ds_read_b64_tr_b16 v[90:91], v6 offset:10656
    ds_read_b64_tr_b16 v[96:97], v6 offset:10240
    ds_read_b64_tr_b16 v[98:99], v6 offset:10784
    ds_read_b64_tr_b16 v[92:93], v6 offset:18816
    ds_read_b64_tr_b16 v[94:95], v6 offset:19360
    ds_read_b64_tr_b16 v[100:101], v6 offset:18944
    ds_read_b64_tr_b16 v[102:103], v6 offset:19488
    ds_read_b64_tr_b16 v[104:105], v6 offset:27520
    ds_read_b64_tr_b16 v[106:107], v6 offset:28064
    ds_read_b64_tr_b16 v[112:113], v6 offset:27648
    ds_read_b64_tr_b16 v[114:115], v6 offset:28192
    ds_read_b64_tr_b16 v[108:109], v6 offset:36224
    ds_read_b64_tr_b16 v[110:111], v6 offset:36768
    ds_read_b64_tr_b16 v[116:117], v6 offset:36352
    ds_read_b64_tr_b16 v[118:119], v6 offset:36896
    ds_read_b64_tr_b16 v[120:121], v6 offset:44928
    ds_read_b64_tr_b16 v[122:123], v6 offset:45472
    ds_read_b64_tr_b16 v[128:129], v6 offset:45056
    ds_read_b64_tr_b16 v[130:131], v6 offset:45600
    ds_read_b64_tr_b16 v[124:125], v6 offset:53632
    ds_read_b64_tr_b16 v[126:127], v6 offset:54176
    ds_read_b64_tr_b16 v[132:133], v6 offset:53760
    ds_read_b64_tr_b16 v[134:135], v6 offset:54304
    s_waitcnt vmcnt(0) lgkmcnt(0)
    v_readfirstlane_b32 s55, v196
    v_readfirstlane_b32 s56, v197
    s_xor_b32 s51, s51, s55
    s_and_b32 s51, s51, 1
    s_lshl_b32 s51, s51, 13
    s_cmp_eq_u32 s56, s43
    s_cselect_b32 s51, s51, 0
    s_and_b32 s55, s39, 3
    s_lshl_b32 s55, s55, 14
    s_add_u32 s55, s55, s51
    s_add_u32 s55, s55, 2097152
    v_lshl_add_u32 v2, v1, 7, s55
    v_xor_b32 v3, 0x4000, v2
    v_xor_b32 v4, 0x8000, v2
    v_xor_b32 v5, 0xc000, v2
    s_add_u32 s55, s51, 3145728
    v_add_u32 v7, s55, v18
    v_lshrrev_b32 v8, 4, v1
    v_bfe_u32 v9, v1, 3, 1
    v_and_b32 v10, 7, v1
    s_lshl_b32 s55, s41, 7
    s_add_u32 s55, s55, s51
    s_add_u32 s55, s55, 2228224
    v_lshl_add_u32 v224, v8, 14, s55
    v_lshl_add_u32 v224, v9, 12, v224
    v_lshl_add_u32 v224, v10, 4, v224
    v_add_u32 v225, 0x10000, v224
    v_add_u32 v226, 0x20000, v224
    v_add_u32 v227, 0x30000, v224
    s_lshl_b32 s55, s41, 5
    v_lshl_add_u32 v228, v10, 2, s55
    s_cmp_lg_u32 s42, 0
    s_cbranch_scc1 L_ffn_w
    s_mov_b32 s54, 0
L_spub:
    ds_read_b32 v9, v11 offset:24
    s_add_u32 s54, s54, 1
    s_cmp_gt_u32 s54, 1048576
    s_waitcnt lgkmcnt(0)
    v_cmp_gt_u32 vcc, 1, v9
    s_cbranch_scc1 L_spub_x
    s_cbranch_vccnz L_spub
L_spub_x:
    s_mov_b32 s54, 0
L_p3:
    global_load_dwordx2 v[192:193], v2, s[36:37] sc1
    global_load_dwordx2 v[194:195], v3, s[36:37] sc1
    global_load_dwordx2 v[196:197], v4, s[36:37] sc1
    global_load_dwordx2 v[198:199], v5, s[36:37] sc1
    s_add_u32 s54, s54, 1
    s_cmp_gt_u32 s54, 262144
    s_waitcnt vmcnt(0)
    s_cbranch_scc1 L_p3_x
    v_xor_b32 v9, v193, v19
    v_bitop3_b32 v9, v195, v19, v9 bitop3:0xbe
    v_bitop3_b32 v9, v197, v19, v9 bitop3:0xbe
    v_bitop3_b32 v9, v199, v19, v9 bitop3:0xbe
    v_cmp_ne_u32 vcc, 0, v9
    s_nop 0
    s_and_b64 exec, exec, vcc
    s_cbranch_execnz L_p3
L_p3_x:
    s_mov_b64 exec, -1
    v_max3_u32 v9, v192, v194, v196
    v_max_u32 v9, v9, v198
    s_nop 1
    v_max_u32_dpp v9, v9, v9 row_shr:1 row_mask:0xf bank_mask:0xf
    s_nop 1
    v_max_u32_dpp v9, v9, v9 row_shr:2 row_mask:0xf bank_mask:0xf
    s_nop 1
    v_max_u32_dpp v9, v9, v9 row_shr:4 row_mask:0xf bank_mask:0xf
    s_nop 1
    v_max_u32_dpp v9, v9, v9 row_shr:8 row_mask:0xf bank_mask:0xf
    s_nop 0
    v_readlane_b32 s55, v9, 15
    v_readlane_b32 s56, v9, 31
    v_readlane_b32 s57, v9, 47
    v_readlane_b32 s58, v9, 63
    s_max_u32 s55, s55, s56
    s_max_u32 s57, s57, s58
    s_max_u32 s52, s55, s57
    s_andn2_b32 s52, 0x7ff, s52
    s_and_b32 s55, s52, 0x7e0
    s_and_b32 s56, s52, 0x7f8
    s_add_u32 s55, s55, s56
    v_lshl_add_u32 v6, s55, 8, v7
    s_mov_b64 exec, 0xfffffff
    s_mov_b32 s54, 0
L_p3r:
    global_load_dwordx4 v[192:195], v6, s[36:37] offset:0 sc1
    global_load_dwordx4 v[196:199], v6, s[36:37] offset:512 sc1
    global_load_dwordx4 v[200:203], v6, s[36:37] offset:1024 sc1
    s_add_u32 s54, s54, 1
    s_cmp_gt_u32 s54, 262144
    s_waitcnt vmcnt(0)
    s_cbranch_scc1 L_p3r_x
    v_xor_b32 v9, v195, v19
    v_bitop3_b32 v9, v199, v19, v9 bitop3:0xbe
    v_bitop3_b32 v9, v203, v19, v9 bitop3:0xbe
    v_cmp_ne_u32 vcc, 0, v9
    s_nop 0
    s_and_b64 exec, exec, vcc
    s_cbranch_execnz L_p3r
L_p3r_x:
    s_mov_b64 exec, 0xfffffff
    v_mov_b32 v195, v196
    v_mov_b32 v199, v198
    v_mov_b32 v198, v197
    ds_write_b128 v18, v[192:195] offset:384
    ds_write_b128 v18, v[198:201] offset:832
    s_mov_b64 exec, 1
    ds_add_u32 v11, v16 offset:332
    s_mov_b64 exec, -1
    s_nop 0
    v_readlane_b32 s46, v202, 16
    v_readlane_b32 s47, v202, 17
    v_readlane_b32 s48, v202, 18
L_ffn_go:
    ds_read_b128 v[192:195], v20 offset:384
    ds_read_b128 v[196:199], v20 offset:512
    ds_read_b128 v[200:203], v20 offset:640
    ds_read_b128 v[204:207], v20 offset:768
    ds_read_b128 v[208:211], v20 offset:896
    ds_read_b128 v[212:215], v20 offset:1024
    ds_read_b128 v[216:219], v20 offset:1152
    s_waitcnt lgkmcnt(6)
    v_smfmac_f32_16x16x64_bf16 v[240:243], v[192:195], v[24:31], v17
    v_smfmac_f32_16x16x64_bf16 v[244:247], v[192:195], v[32:39], v17
    s_waitcnt lgkmcnt(5)
    v_smfmac_f32_16x16x64_bf16 v[240:243], v[196:199], v[40:47], v17
    v_smfmac_f32_16x16x64_bf16 v[244:247], v[196:199], v[48:55], v17
    s_waitcnt lgkmcnt(4)
    v_smfmac_f32_16x16x64_bf16 v[240:243], v[200:203], v[56:63], v17
    v_smfmac_f32_16x16x64_bf16 v[244:247], v[200:203], v[64:71], v17
    s_waitcnt lgkmcnt(3)
    v_smfmac_f32_16x16x64_bf16 v[240:243], v[204:207], v[72:79], v17
    v_smfmac_f32_16x16x64_bf16 v[244:247], v[204:207], v[80:87], v17
    s_waitcnt lgkmcnt(2)
    v_smfmac_f32_16x16x64_bf16 v[240:243], v[208:211], v[88:95], v17
    v_smfmac_f32_16x16x64_bf16 v[244:247], v[208:211], v[96:103], v17
    s_waitcnt lgkmcnt(1)
    v_smfmac_f32_16x16x64_bf16 v[240:243], v[212:215], v[104:111], v17
    v_smfmac_f32_16x16x64_bf16 v[244:247], v[212:215], v[112:119], v17
    s_waitcnt lgkmcnt(0)
    v_smfmac_f32_16x16x64_bf16 v[240:243], v[216:219], v[120:127], v17
    v_smfmac_f32_16x16x64_bf16 v[244:247], v[216:219], v[128:135], v17
    s_mov_b64 exec, 0xffff
    s_nop 9
    v_add_f32 v4, v240, v241
    v_add_f32 v3, v244, v245
    v_mul_f32 v2, 0xbfb8aa3b, v4
    v_exp_f32 v2, v2
    v_mul_f32 v3, v3, v4
    v_add_f32 v2, 1.0, v2
    v_rcp_f32 v2, v2
    s_nop 0
    v_mul_f32 v2, v2, v3
    v_cvt_pk_bf16_f32 v2, v2, v2
    ds_write_b16 v22, v2
    s_mov_b64 exec, -1
    s_waitcnt lgkmcnt(0)
    s_barrier
    ds_read_b128 v[192:195], v12
    ds_read_b128 v[196:199], v13
    ds_read_b128 v[200:203], v14
    ds_read_b128 v[204:207], v15
    v_mov_b32 v3, s43
    v_mov_b32 v5, s43
    s_waitcnt lgkmcnt(3)
    v_smfmac_f32_16x16x64_bf16 v[252:255], v[192:195], v[168:175], v17
    v_smfmac_f32_16x16x64_bf16 v[248:251], v[192:195], v[136:143], v17
    s_waitcnt lgkmcnt(2)
    v_smfmac_f32_16x16x64_bf16 v[252:255], v[196:199], v[176:183], v17
    v_smfmac_f32_16x16x64_bf16 v[248:251], v[196:199], v[144:151], v17
    s_waitcnt lgkmcnt(1)
    v_smfmac_f32_16x16x64_bf16 v[252:255], v[200:203], v[184:191], v17
    v_smfmac_f32_16x16x64_bf16 v[248:251], v[200:203], v[152:159], v17
    s_waitcnt lgkmcnt(0)
    v_smfmac_f32_16x16x64_bf16 v[248:251], v[204:207], v[160:167], v17
    s_cmp_lg_u32 s42, 0
    s_nop 7
    v_add_f32 v4, v252, v253
    s_nop 1
    v_add_f32 v2, v248, v249
    global_store_dwordx2 v23, v[2:3], s[36:37] sc1
    global_store_dwordx2 v21, v[2:3], s[36:37] sc1
    s_mov_b32 exec_hi, 0xffff
    global_store_dwordx2 v23, v[4:5], s[36:37] offset:512 sc1
    global_store_dwordx2 v21, v[4:5], s[36:37] offset:512 sc1
    s_mov_b64 exec, -1
    s_cbranch_scc1 L_fin
    ds_read_b32 v46, v228 offset:384
    s_and_b32 s55, s52, 0x600
    s_and_b32 s56, s52, 0x7f8
    s_add_u32 s55, s55, s56
    s_lshl_b32 s55, s55, 4
    s_add_u32 s55, s55, s51
    s_add_u32 s55, s55, 2162688
    s_mov_b32 exec_lo, 0
    v_mov_b32 v227, s55
    s_mov_b32 exec_lo, -1
    s_mul_i32 s56, s52, 896
    v_add_u32 v27, s56, v228
    v_mov_b32 v44, 0xbfb8aa3b
    v_mul_f32 v44, s46, v44
    v_exp_f32 v44, v44
    v_mov_b32 v50, s47
    v_add_f32 v44, 1.0, v44
    v_rcp_f32 v44, v44
    s_waitcnt lgkmcnt(0)
    v_lshlrev_b32 v48, 16, v46
    v_and_b32 v49, 0xffff0000, v46
    v_fma_f32 v48, v48, s48, v50
    v_fma_f32 v49, v49, s48, v50
    s_waitcnt vmcnt(0)
    s_mov_b32 s54, 0
L_p4:
    global_load_dwordx4 v[28:31], v224, s[36:37] sc1
    global_load_dwordx4 v[32:35], v225, s[36:37] sc1
    global_load_dwordx4 v[36:39], v226, s[36:37] sc1
    global_load_dwordx4 v[40:43], v227, s[36:37] sc1
    s_add_u32 s54, s54, 1
    s_cmp_gt_u32 s54, 262144
    s_waitcnt vmcnt(0)
    s_cbranch_scc1 L_p4_x
    v_xor_b32 v9, v29, v19
    v_bitop3_b32 v9, v31, v19, v9 bitop3:0xbe
    v_bitop3_b32 v9, v33, v19, v9 bitop3:0xbe
    v_bitop3_b32 v9, v35, v19, v9 bitop3:0xbe
    v_bitop3_b32 v9, v37, v19, v9 bitop3:0xbe
    v_bitop3_b32 v9, v39, v19, v9 bitop3:0xbe
    v_bitop3_b32 v9, v41, v19, v9 bitop3:0xbe
    v_bitop3_b32 v9, v43, v19, v9 bitop3:0xbe
    v_cmp_ne_u32 vcc, 0, v9
    s_nop 0
    s_and_b64 exec, exec, vcc
    s_cbranch_execnz L_p4
L_p4_x:
    s_mov_b64 exec, -1
    v_add_f32 v28, v28, v32
    v_add_f32 v30, v30, v34
    s_mov_b32 exec_hi, 0
    v_add_f32 v36, v36, v40
    v_add_f32 v38, v38, v42
    s_mov_b32 exec_hi, -1
    v_add_f32 v28, v28, v36
    v_add_f32 v30, v30, v38
    s_nop 1
    v_permlane32_swap_b32 v28, v30
    v_add_f32 v28, v28, v30
    s_nop 1
    v_add_f32_dpp v28, v28, v28 row_ror:8 row_mask:0xf bank_mask:0xf
    v_mov_b32 v29, v28
    s_nop 1
    v_permlane16_swap_b32 v28, v29
    v_add_f32 v28, v28, v29
    v_mov_b32 v29, v28
    s_nop 1
    v_permlane32_swap_b32 v28, v29
    v_pk_fma_f32 v[28:29], v[28:29], v[44:45], v[48:49] op_sel_hi:[1,0,1]
    v_cvt_pk_bf16_f32 v28, v28, v29
    s_mov_b64 exec, 0xff
    global_store_dword v27, v28, s[32:33] sc1
L_fin:
L_end:
    s_endpgm
L_idle:
    s_lshl_b32 s55, s39, 2
    s_add_u32 s55, s55, s42
    s_cmp_lg_u32 s55, 112
    s_cbranch_scc1 L_fin
    v_add_u32 v2, 2506752, v18
    v_add_u32 v3, 0x2000, v2
    s_mov_b64 exec, 0xff
    s_mov_b32 s26, -1
    s_mov_b32 s27, -1
    s_memtime s[28:29]
    s_waitcnt lgkmcnt(0)
    global_store_dwordx4 v2, v[8:11], s[36:37] sc1
    s_waitcnt vmcnt(0)
    s_memtime s[30:31]
    s_waitcnt lgkmcnt(0)
    s_sub_u32 s30, s30, s28
    s_min_u32 s26, s26, s30
    s_memtime s[28:29]
    s_waitcnt lgkmcnt(0)
    global_store_dwordx4 v3, v[8:11], s[36:37] sc1
    s_waitcnt vmcnt(0)
    s_memtime s[30:31]
    s_waitcnt lgkmcnt(0)
    s_sub_u32 s30, s30, s28
    s_min_u32 s27, s27, s30
    s_memtime s[28:29]
    s_waitcnt lgkmcnt(0)
    global_store_dwordx4 v2, v[8:11], s[36:37] sc1
    s_waitcnt vmcnt(0)
    s_memtime s[30:31]
    s_waitcnt lgkmcnt(0)
    s_sub_u32 s30, s30, s28
    s_min_u32 s26, s26, s30
    s_memtime s[28:29]
    s_waitcnt lgkmcnt(0)
    global_store_dwordx4 v3, v[8:11], s[36:37] sc1
    s_waitcnt vmcnt(0)
    s_memtime s[30:31]
    s_waitcnt lgkmcnt(0)
    s_sub_u32 s30, s30, s28
    s_min_u32 s27, s27, s30
    s_memtime s[28:29]
    s_waitcnt lgkmcnt(0)
    global_store_dwordx4 v2, v[8:11], s[36:37] sc1
    s_waitcnt vmcnt(0)
    s_memtime s[30:31]
    s_waitcnt lgkmcnt(0)
    s_sub_u32 s30, s30, s28
    s_min_u32 s26, s26, s30
    s_memtime s[28:29]
    s_waitcnt lgkmcnt(0)
    global_store_dwordx4 v3, v[8:11], s[36:37] sc1
    s_waitcnt vmcnt(0)
    s_memtime s[30:31]
    s_waitcnt lgkmcnt(0)
    s_sub_u32 s30, s30, s28
    s_min_u32 s27, s27, s30
    s_memtime s[28:29]
    s_waitcnt lgkmcnt(0)
    global_store_dwordx4 v2, v[8:11], s[36:37] sc1
    s_waitcnt vmcnt(0)
    s_memtime s[30:31]
    s_waitcnt lgkmcnt(0)
    s_sub_u32 s30, s30, s28
    s_min_u32 s26, s26, s30
    s_memtime s[28:29]
    s_waitcnt lgkmcnt(0)
    global_store_dwordx4 v3, v[8:11], s[36:37] sc1
    s_waitcnt vmcnt(0)
    s_memtime s[30:31]
    s_waitcnt lgkmcnt(0)
    s_sub_u32 s30, s30, s28
    s_min_u32 s27, s27, s30
    s_cmp_lt_u32 s27, s26
    s_cselect_b32 s55, 1, 0
    s_xor_b32 s55, s55, s51
    v_mov_b32 v4, s55
    v_mov_b32 v5, s43
    v_mov_b32 v6, s55
    v_mov_b32 v7, s43
    v_add_u32 v2, 2490368, v18
    global_store_dwordx4 v2, v[4:7], s[36:37] sc1
    s_branch L_fin
L_p1_retry:
    s_wqm_b64 exec, vcc
    s_mov_b32 s54, 0
L_p1:
    global_load_dwordx4 v[180:183], v170, s[36:37] sc1
    global_load_dwordx4 v[184:187], v171, s[36:37] sc1
    s_add_u32 s54, s54, 1
    s_cmp_gt_u32 s54, 262144
    s_waitcnt vmcnt(0)
    s_cbranch_scc1 L_p1_x
    v_xor_b32 v180, v180, v196
    v_xor_b32 v181, v181, v197
    v_xor_b32 v182, v182, v198
    v_xor_b32 v183, v183, v199
    v_xor_b32 v184, v184, v196
    v_xor_b32 v185, v185, v197
    v_xor_b32 v186, v186, v198
    v_xor_b32_e64 v187, v187, v199
    v_or3_b32 v176, v180, v181, v182
    v_or3_b32 v13, v183, v184, v185
    v_or3_b32 v176, v176, v186, v187
    v_bitop3_b32 v176, v176, v13, s52 bitop3:0xa8
    v_cmp_ne_u32 vcc, 0, v176
    s_nop 0
    s_wqm_b64 vcc, vcc
    s_and_b64 exec, exec, vcc
    s_cbranch_execnz L_p1
L_p1_x:
    s_mov_b64 exec, -1
    s_branch L_p1_ok
L_p2_retry:
    s_wqm_b64 exec, vcc
    s_mov_b32 s54, 0
L_p2:
    global_load_dwordx4 v[64:67], v173, s[36:37] sc1
    global_load_dwordx4 v[68:71], v174, s[36:37] sc1
    s_add_u32 s54, s54, 1
    s_cmp_gt_u32 s54, 262144
    s_waitcnt vmcnt(0)
    s_cbranch_scc1 L_p2_x
    v_xor_b32 v64, v64, v196
    v_xor_b32 v65, v65, v197
    v_xor_b32 v66, v66, v198
    v_xor_b32 v67, v67, v199
    v_xor_b32 v68, v68, v196
    v_xor_b32 v69, v69, v197
    v_xor_b32 v70, v70, v198
    v_xor_b32 v71, v71, v199
    v_or3_b32 v176, v64, v65, v66
    v_or3_b32 v13, v67, v68, v69
    v_or3_b32 v176, v176, v70, v71
    v_bitop3_b32 v176, v176, v13, s52 bitop3:0xa8
    v_cmp_ne_u32 vcc, 0, v176
    s_nop 0
    s_wqm_b64 vcc, vcc
    s_and_b64 exec, exec, vcc
    s_cbranch_execnz L_p2
L_p2_x:
    s_mov_b64 exec, s[46:47]
    s_branch L_p2_ok
L_f_retry:
    s_mov_b32 s54, 0
L_fsp:
    ds_read_b32 v54, v21 offset:48
    s_add_u32 s54, s54, 1
    s_cmp_gt_u32 s54, 1048576
    s_waitcnt lgkmcnt(0)
    v_cmp_gt_u32 vcc, 1, v54
    s_cbranch_scc1 L_fsp_x
    s_cbranch_vccnz L_fsp
L_fsp_x:
    s_cbranch_scc0 L_f_again
    s_branch L_end
L_t_retry:
    s_mov_b32 s54, 0
L_st:
    ds_read_b32 v54, v20 offset:4
    ds_read_b64 v[24:25], v136
    ds_read_b64 v[26:27], v137
    ds_read_b64 v[28:29], v138
    ds_read_b64 v[30:31], v139
    ds_read_b64 v[32:33], v140
    ds_read_b64 v[34:35], v141
    ds_read_b64 v[36:37], v142
    ds_read_b64 v[38:39], v143
    ds_read_b64 v[40:41], v144
    ds_read_b64 v[42:43], v145
    ds_read_b64 v[44:45], v146
    s_add_u32 s54, s54, 1
    s_cmp_gt_u32 s54, 1048576
    s_waitcnt lgkmcnt(0)
    v_cmp_gt_u32 vcc, 2, v54
    s_cbranch_scc1 L_st_x
    s_cbranch_vccnz L_st
L_st_x:
    s_branch L_t_ok
L_u_retry:
    s_mov_b32 s54, 0
L_usp0:
    ds_read_b32 v22, v11 offset:320
    s_add_u32 s54, s54, 1
    s_cmp_gt_u32 s54, 1048576
    s_waitcnt lgkmcnt(0)
    v_cmp_gt_u32 vcc, 3, v22
    s_cbranch_scc1 L_usp0_x
    s_cbranch_vccnz L_usp0
L_usp0_x:
    s_mov_b32 s54, 0
L_usp:
    ds_read_b32 v22, v11 offset:320
    ds_read_b64 v[152:153], v17 offset:0
    ds_read_b64 v[154:155], v17 offset:8
    ds_read_b64 v[156:157], v17 offset:512
    ds_read_b64 v[158:159], v17 offset:520
    ds_read_b64 v[160:161], v17 offset:1024
    ds_read_b64 v[162:163], v17 offset:1032
    s_add_u32 s54, s54, 1
    s_cmp_gt_u32 s54, 1048576
    s_waitcnt lgkmcnt(0)
    v_cmp_gt_u32 vcc, 4, v22
    s_cbranch_scc1 L_usp_x
    s_cbranch_vccnz L_usp
L_usp_x:
    s_branch L_u_ok
L_ffn_w:
    s_mov_b32 s54, 0
L_sx:
    ds_read_b32 v9, v11 offset:332
    s_add_u32 s54, s54, 1
    s_cmp_gt_u32 s54, 1048576
    s_waitcnt lgkmcnt(0)
    v_cmp_gt_u32 vcc, 1, v9
    s_cbranch_scc1 L_sx_x
    s_cbranch_vccnz L_sx
L_sx_x:
    s_branch L_ffn_go
.p2align 7
.type L_table,@object
L_table:
.short 2736, 2992, 3248, 1464, 1720, 1976, 2232, 2488
.short 2728, 2984, 3240, 1456, 1712, 1968, 2224, 2480
.short 2720, 2976, 3232, 1448, 1704, 1960, 2216, 2472
.short 2712, 2968, 3224, 1440, 1696, 1952, 2208, 2464
.short 2864, 3120, 3376, 1592, 1848, 2104, 2360, 2616
.short 2856, 3112, 3368, 1584, 1840, 2096, 2352, 2608
.short 2848, 3104, 3360, 1576, 1832, 2088, 2344, 2600
.short 2840, 3096, 3352, 1568, 1824, 2080, 2336, 2592
.short 2800, 3056, 3312, 1528, 1784, 2040, 2296, 2552
.short 2792, 3048, 3304, 1520, 1776, 2032, 2288, 2544
.short 2784, 3040, 3296, 1512, 1768, 2024, 2280, 2536
.short 2776, 3032, 3288, 1504, 1760, 2016, 2272, 2528
.short 2928, 3184, 3440, 1656, 1912, 2168, 2424, 2680
.short 2920, 3176, 3432, 1648, 1904, 2160, 2416, 2672
.short 2912, 3168, 3424, 1640, 1896, 2152, 2408, 2664
.short 2904, 3160, 3416, 1632, 1888, 2144, 2400, 2656
.short 4016, 4272, 3512, 3512, 3512, 3768, 4024, 4024
.short 4008, 4264, 3504, 3504, 3504, 3760, 4016, 4016
.short 4000, 4256, 3496, 3496, 3496, 3752, 4008, 4008
.short 3992, 4248, 3488, 3488, 3488, 3744, 4000, 4000
.short 4144, 4400, 3640, 3640, 3640, 3896, 4152, 4152
.short 4136, 4392, 3632, 3632, 3632, 3888, 4144, 4144
.short 4128, 4384, 3624, 3624, 3624, 3880, 4136, 4136
.short 4120, 4376, 3616, 3616, 3616, 3872, 4128, 4128
.short 4080, 4336, 3576, 3576, 3576, 3832, 4088, 4088
.short 4072, 4328, 3568, 3568, 3568, 3824, 4080, 4080
.short 4064, 4320, 3560, 3560, 3560, 3816, 4072, 4072
.short 4056, 4312, 3552, 3552, 3552, 3808, 4064, 4064
.short 4208, 4464, 3704, 3704, 3704, 3960, 4216, 4216
.short 4200, 4456, 3696, 3696, 3696, 3952, 4208, 4208
.short 4192, 4448, 3688, 3688, 3688, 3944, 4200, 4200
.short 4184, 4440, 3680, 3680, 3680, 3936, 4192, 4192
.short 4784, 4536, 4536, 4536, 4536, 4536, 4792, 4792
.short 4776, 4528, 4528, 4528, 4528, 4528, 4784, 4784
.short 4768, 4520, 4520, 4520, 4520, 4520, 4776, 4776
.short 4760, 4512, 4512, 4512, 4512, 4512, 4768, 4768
.short 4912, 4664, 4664, 4664, 4664, 4664, 4920, 4920
.short 4904, 4656, 4656, 4656, 4656, 4656, 4912, 4912
.short 4896, 4648, 4648, 4648, 4648, 4648, 4904, 4904
.short 4888, 4640, 4640, 4640, 4640, 4640, 4896, 4896
.short 4848, 4600, 4600, 4600, 4600, 4600, 4856, 4856
.short 4840, 4592, 4592, 4592, 4592, 4592, 4848, 4848
.short 4832, 4584, 4584, 4584, 4584, 4584, 4840, 4840
.short 4824, 4576, 4576, 4576, 4576, 4576, 4832, 4832
.short 4976, 4728, 4728, 4728, 4728, 4728, 4984, 4984
.short 4968, 4720, 4720, 4720, 4720, 4720, 4976, 4976
.short 4960, 4712, 4712, 4712, 4712, 4712, 4968, 4968
.short 4952, 4704, 4704, 4704, 4704, 4704, 4960, 4960
.short 5296, 5048, 5048, 5048, 5048, 5048, 5304, 5304
.short 5288, 5040, 5040, 5040, 5040, 5040, 5296, 5296
.short 5280, 5032, 5032, 5032, 5032, 5032, 5288, 5288
.short 5272, 5024, 5024, 5024, 5024, 5024, 5280, 5280
.short 5424, 5176, 5176, 5176, 5176, 5176, 5432, 5432
.short 5416, 5168, 5168, 5168, 5168, 5168, 5424, 5424
.short 5408, 5160, 5160, 5160, 5160, 5160, 5416, 5416
.short 5400, 5152, 5152, 5152, 5152, 5152, 5408, 5408
.short 5360, 5112, 5112, 5112, 5112, 5112, 5368, 5368
.short 5352, 5104, 5104, 5104, 5104, 5104, 5360, 5360
.short 5344, 5096, 5096, 5096, 5096, 5096, 5352, 5352
.short 5336, 5088, 5088, 5088, 5088, 5088, 5344, 5344
.short 5488, 5240, 5240, 5240, 5240, 5240, 5496, 5496
.short 5480, 5232, 5232, 5232, 5232, 5232, 5488, 5488
.short 5472, 5224, 5224, 5224, 5224, 5224, 5480, 5480
.short 5464, 5216, 5216, 5216, 5216, 5216, 5472, 5472
.short 2744, 3000, 3256, 5560, 5560, 5568, 5568, 15072
.short 2736, 2992, 3248, 5552, 5552, 5552, 5560, 15088
.short 2728, 2984, 3240, 5544, 5544, 5552, 5552, 15104
.short 2720, 2976, 3232, 5536, 5536, 5536, 5544, 15120
.short 2872, 3128, 3384, 5688, 5688, 5696, 5696, 15648
.short 2864, 3120, 3376, 5680, 5680, 5680, 5688, 15664
.short 2856, 3112, 3368, 5672, 5672, 5680, 5680, 15680
.short 2848, 3104, 3360, 5664, 5664, 5664, 5672, 15696
.short 2808, 3064, 3320, 5624, 5624, 5632, 5632, 15360
.short 2800, 3056, 3312, 5616, 5616, 5616, 5624, 15376
.short 2792, 3048, 3304, 5608, 5608, 5616, 5616, 15392
.short 2784, 3040, 3296, 5600, 5600, 5600, 5608, 15408
.short 2936, 3192, 3448, 5752, 5752, 5760, 5760, 15936
.short 2928, 3184, 3440, 5744, 5744, 5744, 5752, 15952
.short 2920, 3176, 3432, 5736, 5736, 5744, 5744, 15968
.short 2912, 3168, 3424, 5728, 5728, 5728, 5736, 15984
.short 4024, 4280, 3520, 5816, 5816, 5824, 5824, 16224
.short 4016, 4272, 3512, 5808, 5808, 5808, 5816, 16240
.short 4008, 4264, 3504, 5800, 5800, 5808, 5808, 16256
.short 4000, 4256, 3496, 5792, 5792, 5792, 5800, 16272
.short 4152, 4408, 3648, 5944, 5944, 5952, 5952, 16800
.short 4144, 4400, 3640, 5936, 5936, 5936, 5944, 16816
.short 4136, 4392, 3632, 5928, 5928, 5936, 5936, 16832
.short 4128, 4384, 3624, 5920, 5920, 5920, 5928, 16848
.short 4088, 4344, 3584, 5880, 5880, 5888, 5888, 16512
.short 4080, 4336, 3576, 5872, 5872, 5872, 5880, 16528
.short 4072, 4328, 3568, 5864, 5864, 5872, 5872, 16544
.short 4064, 4320, 3560, 5856, 5856, 5856, 5864, 16560
.short 4216, 4472, 4480, 6008, 6008, 6016, 6016, 17088
.short 4208, 4464, 3704, 6000, 6000, 6000, 6008, 17104
.short 4200, 4456, 3696, 5992, 5992, 6000, 6000, 17120
.short 4192, 4448, 3688, 5984, 5984, 5984, 5992, 17136
.short 4792, 4544, 4544, 6072, 6072, 6080, 6080, 17376
.short 4784, 4536, 4536, 6064, 6064, 6064, 6072, 17392
.short 4776, 4528, 4528, 6056, 6056, 6064, 6064, 17408
.short 4768, 4520, 4520, 6048, 6048, 6048, 6056, 17424
.short 4920, 4672, 4672, 6200, 6200, 6208, 6208, 17952
.short 4912, 4664, 4664, 6192, 6192, 6192, 6200, 17968
.short 4904, 4656, 4656, 6184, 6184, 6192, 6192, 17984
.short 4896, 4648, 4648, 6176, 6176, 6176, 6184, 18000
.short 4856, 4608, 4608, 6136, 6136, 6144, 6144, 17664
.short 4848, 4600, 4600, 6128, 6128, 6128, 6136, 17680
.short 4840, 4592, 4592, 6120, 6120, 6128, 6128, 17696
.short 4832, 4584, 4584, 6112, 6112, 6112, 6120, 17712
.short 4984, 4992, 4992, 6264, 6264, 6272, 6272, 18240
.short 4976, 4728, 4728, 6256, 6256, 6256, 6264, 18256
.short 4968, 4720, 4720, 6248, 6248, 6256, 6256, 18272
.short 4960, 4712, 4712, 6240, 6240, 6240, 6248, 18288
.short 5304, 5056, 5056, 6328, 6328, 6336, 6336, 18528
.short 5296, 5048, 5048, 6320, 6320, 6320, 6328, 18544
.short 5288, 5040, 5040, 6312, 6312, 6320, 6320, 18560
.short 5280, 5032, 5032, 6304, 6304, 6304, 6312, 18576
.short 5432, 5184, 5184, 6456, 6456, 6464, 6464, 19104
.short 5424, 5176, 5176, 6448, 6448, 6448, 6456, 19120
.short 5416, 5168, 5168, 6440, 6440, 6448, 6448, 19136
.short 5408, 5160, 5160, 6432, 6432, 6432, 6440, 19152
.short 5368, 5120, 5120, 6392, 6392, 6400, 6400, 18816
.short 5360, 5112, 5112, 6384, 6384, 6384, 6392, 18832
.short 5352, 5104, 5104, 6376, 6376, 6384, 6384, 18848
.short 5344, 5096, 5096, 6368, 6368, 6368, 6376, 18864
.short 5496, 5504, 5504, 6520, 6520, 6528, 6528, 19392
.short 5488, 5240, 5240, 6512, 6512, 6512, 6520, 19408
.short 5480, 5232, 5232, 6504, 6504, 6512, 6512, 19424
.short 5472, 5224, 5224, 6496, 6496, 6496, 6504, 19440
.short 2704, 2960, 3216, 1432, 1688, 1944, 2200, 2456
.short 2696, 2952, 3208, 1424, 1680, 1936, 2192, 2448
.short 2688, 2944, 3200, 1416, 1672, 1928, 2184, 2440
.short 192, 192, 192, 1408, 1664, 1920, 2176, 2432
.short 2832, 3088, 3344, 1560, 1816, 2072, 2328, 2584
.short 2824, 3080, 3336, 1552, 1808, 2064, 2320, 2576
.short 2816, 3072, 3328, 1544, 1800, 2056, 2312, 2568
.short 2808, 3064, 3320, 1536, 1792, 2048, 2304, 2560
.short 2768, 3024, 3280, 1496, 1752, 2008, 2264, 2520
.short 2760, 3016, 3272, 1488, 1744, 2000, 2256, 2512
.short 2752, 3008, 3264, 1480, 1736, 1992, 2248, 2504
.short 2744, 3000, 3256, 1472, 1728, 1984, 2240, 2496
.short 2896, 3152, 3408, 1624, 1880, 2136, 2392, 2648
.short 2888, 3144, 3400, 1616, 1872, 2128, 2384, 2640
.short 2880, 3136, 3392, 1608, 1864, 2120, 2376, 2632
.short 2872, 3128, 3384, 1600, 1856, 2112, 2368, 2624
.short 3984, 4240, 3480, 3480, 3480, 3736, 3992, 3992
.short 3976, 4232, 3472, 3472, 3472, 3728, 3984, 3984
.short 3968, 4224, 3464, 3464, 3464, 3720, 3976, 3976
.short 2936, 3192, 3448, 3456, 3456, 3712, 3968, 3968
.short 4112, 4368, 3608, 3608, 3608, 3864, 4120, 4120
.short 4104, 4360, 3600, 3600, 3600, 3856, 4112, 4112
.short 4096, 4352, 3592, 3592, 3592, 3848, 4104, 4104
.short 4088, 4344, 3584, 3584, 3584, 3840, 4096, 4096
.short 4048, 4304, 3544, 3544, 3544, 3800, 4056, 4056
.short 4040, 4296, 3536, 3536, 3536, 3792, 4048, 4048
.short 4032, 4288, 3528, 3528, 3528, 3784, 4040, 4040
.short 4024, 4280, 3520, 3520, 3520, 3776, 4032, 4032
.short 4176, 4432, 3672, 3672, 3672, 3928, 4184, 4184
.short 4168, 4424, 3664, 3664, 3664, 3920, 4176, 4176
.short 4160, 4416, 3656, 3656, 3656, 3912, 4168, 4168
.short 4152, 4408, 3648, 3648, 3648, 3904, 4160, 4160
.short 4752, 4504, 4504, 4504, 4504, 4504, 4760, 4760
.short 4744, 4496, 4496, 4496, 4496, 4496, 4752, 4752
.short 4736, 4488, 4488, 4488, 4488, 4488, 4744, 4744
.short 4216, 4472, 4480, 4480, 4480, 4480, 4736, 4736
.short 4880, 4632, 4632, 4632, 4632, 4632, 4888, 4888
.short 4872, 4624, 4624, 4624, 4624, 4624, 4880, 4880
.short 4864, 4616, 4616, 4616, 4616, 4616, 4872, 4872
.short 4856, 4608, 4608, 4608, 4608, 4608, 4864, 4864
.short 4816, 4568, 4568, 4568, 4568, 4568, 4824, 4824
.short 4808, 4560, 4560, 4560, 4560, 4560, 4816, 4816
.short 4800, 4552, 4552, 4552, 4552, 4552, 4808, 4808
.short 4792, 4544, 4544, 4544, 4544, 4544, 4800, 4800
.short 4944, 4696, 4696, 4696, 4696, 4696, 4952, 4952
.short 4936, 4688, 4688, 4688, 4688, 4688, 4944, 4944
.short 4928, 4680, 4680, 4680, 4680, 4680, 4936, 4936
.short 4920, 4672, 4672, 4672, 4672, 4672, 4928, 4928
.short 5264, 5016, 5016, 5016, 5016, 5016, 5272, 5272
.short 5256, 5008, 5008, 5008, 5008, 5008, 5264, 5264
.short 5248, 5000, 5000, 5000, 5000, 5000, 5256, 5256
.short 4984, 4992, 4992, 4992, 4992, 4992, 5248, 5248
.short 5392, 5144, 5144, 5144, 5144, 5144, 5400, 5400
.short 5384, 5136, 5136, 5136, 5136, 5136, 5392, 5392
.short 5376, 5128, 5128, 5128, 5128, 5128, 5384, 5384
.short 5368, 5120, 5120, 5120, 5120, 5120, 5376, 5376
.short 5328, 5080, 5080, 5080, 5080, 5080, 5336, 5336
.short 5320, 5072, 5072, 5072, 5072, 5072, 5328, 5328
.short 5312, 5064, 5064, 5064, 5064, 5064, 5320, 5320
.short 5304, 5056, 5056, 5056, 5056, 5056, 5312, 5312
.short 5456, 5208, 5208, 5208, 5208, 5208, 5464, 5464
.short 5448, 5200, 5200, 5200, 5200, 5200, 5456, 5456
.short 5440, 5192, 5192, 5192, 5192, 5192, 5448, 5448
.short 5432, 5184, 5184, 5184, 5184, 5184, 5440, 5440
.short 2712, 2968, 3224, 5528, 5528, 5536, 5536, 29488
.short 2704, 2960, 3216, 5520, 5520, 5520, 5528, 29504
.short 2696, 2952, 3208, 5512, 5512, 5520, 5520, 29520
.short 2688, 2944, 3200, 5496, 5504, 5504, 5512, 29536
.short 2840, 3096, 3352, 5656, 5656, 5664, 5664, 30064
.short 2832, 3088, 3344, 5648, 5648, 5648, 5656, 30080
.short 2824, 3080, 3336, 5640, 5640, 5648, 5648, 30096
.short 2816, 3072, 3328, 5632, 5632, 5632, 5640, 30112
.short 2776, 3032, 3288, 5592, 5592, 5600, 5600, 29776
.short 2768, 3024, 3280, 5584, 5584, 5584, 5592, 29792
.short 2760, 3016, 3272, 5576, 5576, 5584, 5584, 29808
.short 2752, 3008, 3264, 5568, 5568, 5568, 5576, 29824
.short 2904, 3160, 3416, 5720, 5720, 5728, 5728, 30352
.short 2896, 3152, 3408, 5712, 5712, 5712, 5720, 30368
.short 2888, 3144, 3400, 5704, 5704, 5712, 5712, 30384
.short 2880, 3136, 3392, 5696, 5696, 5696, 5704, 30400
.short 3992, 4248, 3488, 5784, 5784, 5792, 5792, 30640
.short 3984, 4240, 3480, 5776, 5776, 5776, 5784, 30656
.short 3976, 4232, 3472, 5768, 5768, 5776, 5776, 30672
.short 3968, 4224, 3464, 5760, 5760, 5760, 5768, 30688
.short 4120, 4376, 3616, 5912, 5912, 5920, 5920, 31216
.short 4112, 4368, 3608, 5904, 5904, 5904, 5912, 31232
.short 4104, 4360, 3600, 5896, 5896, 5904, 5904, 31248
.short 4096, 4352, 3592, 5888, 5888, 5888, 5896, 31264
.short 4056, 4312, 3552, 5848, 5848, 5856, 5856, 30928
.short 4048, 4304, 3544, 5840, 5840, 5840, 5848, 30944
.short 4040, 4296, 3536, 5832, 5832, 5840, 5840, 30960
.short 4032, 4288, 3528, 5824, 5824, 5824, 5832, 30976
.short 4184, 4440, 3680, 5976, 5976, 5984, 5984, 31504
.short 4176, 4432, 3672, 5968, 5968, 5968, 5976, 31520
.short 4168, 4424, 3664, 5960, 5960, 5968, 5968, 31536
.short 4160, 4416, 3656, 5952, 5952, 5952, 5960, 31552
.short 4760, 4512, 4512, 6040, 6040, 6048, 6048, 31792
.short 4752, 4504, 4504, 6032, 6032, 6032, 6040, 31808
.short 4744, 4496, 4496, 6024, 6024, 6032, 6032, 31824
.short 4736, 4488, 4488, 6016, 6016, 6016, 6024, 31840
.short 4888, 4640, 4640, 6168, 6168, 6176, 6176, 32368
.short 4880, 4632, 4632, 6160, 6160, 6160, 6168, 32384
.short 4872, 4624, 4624, 6152, 6152, 6160, 6160, 32400
.short 4864, 4616, 4616, 6144, 6144, 6144, 6152, 32416
.short 4824, 4576, 4576, 6104, 6104, 6112, 6112, 32080
.short 4816, 4568, 4568, 6096, 6096, 6096, 6104, 32096
.short 4808, 4560, 4560, 6088, 6088, 6096, 6096, 32112
.short 4800, 4552, 4552, 6080, 6080, 6080, 6088, 32128
.short 4952, 4704, 4704, 6232, 6232, 6240, 6240, 32656
.short 4944, 4696, 4696, 6224, 6224, 6224, 6232, 32672
.short 4936, 4688, 4688, 6216, 6216, 6224, 6224, 32688
.short 4928, 4680, 4680, 6208, 6208, 6208, 6216, 32704
.short 5272, 5024, 5024, 6296, 6296, 6304, 6304, 32944
.short 5264, 5016, 5016, 6288, 6288, 6288, 6296, 32960
.short 5256, 5008, 5008, 6280, 6280, 6288, 6288, 32976
.short 5248, 5000, 5000, 6272, 6272, 6272, 6280, 32992
.short 5400, 5152, 5152, 6424, 6424, 6432, 6432, 33520
.short 5392, 5144, 5144, 6416, 6416, 6416, 6424, 33536
.short 5384, 5136, 5136, 6408, 6408, 6416, 6416, 33552
.short 5376, 5128, 5128, 6400, 6400, 6400, 6408, 33568
.short 5336, 5088, 5088, 6360, 6360, 6368, 6368, 33232
.short 5328, 5080, 5080, 6352, 6352, 6352, 6360, 33248
.short 5320, 5072, 5072, 6344, 6344, 6352, 6352, 33264
.short 5312, 5064, 5064, 6336, 6336, 6336, 6344, 33280
.short 5464, 5216, 5216, 6488, 6488, 6496, 6496, 33808
.short 5456, 5208, 5208, 6480, 6480, 6480, 6488, 33824
.short 5448, 5200, 5200, 6472, 6472, 6480, 6480, 33840
.short 5440, 5192, 5192, 6464, 6464, 6464, 6472, 33856
.short 9136, 9392, 9648, 7864, 8120, 8376, 8632, 8888
.short 9128, 9384, 9640, 7856, 8112, 8368, 8624, 8880
.short 9120, 9376, 9632, 7848, 8104, 8360, 8616, 8872
.short 9112, 9368, 9624, 7840, 8096, 8352, 8608, 8864
.short 9264, 9520, 9776, 7992, 8248, 8504, 8760, 9016
.short 9256, 9512, 9768, 7984, 8240, 8496, 8752, 9008
.short 9248, 9504, 9760, 7976, 8232, 8488, 8744, 9000
.short 9240, 9496, 9752, 7968, 8224, 8480, 8736, 8992
.short 9200, 9456, 9712, 7928, 8184, 8440, 8696, 8952
.short 9192, 9448, 9704, 7920, 8176, 8432, 8688, 8944
.short 9184, 9440, 9696, 7912, 8168, 8424, 8680, 8936
.short 9176, 9432, 9688, 7904, 8160, 8416, 8672, 8928
.short 9328, 9584, 9840, 8056, 8312, 8568, 8824, 9080
.short 9320, 9576, 9832, 8048, 8304, 8560, 8816, 9072
.short 9312, 9568, 9824, 8040, 8296, 8552, 8808, 9064
.short 9304, 9560, 9816, 8032, 8288, 8544, 8800, 9056
.short 10416, 10672, 9912, 9912, 9912, 10168, 10424, 10424
.short 10408, 10664, 9904, 9904, 9904, 10160, 10416, 10416
.short 10400, 10656, 9896, 9896, 9896, 10152, 10408, 10408
.short 10392, 10648, 9888, 9888, 9888, 10144, 10400, 10400
.short 10544, 10800, 10040, 10040, 10040, 10296, 10552, 10552
.short 10536, 10792, 10032, 10032, 10032, 10288, 10544, 10544
.short 10528, 10784, 10024, 10024, 10024, 10280, 10536, 10536
.short 10520, 10776, 10016, 10016, 10016, 10272, 10528, 10528
.short 10480, 10736, 9976, 9976, 9976, 10232, 10488, 10488
.short 10472, 10728, 9968, 9968, 9968, 10224, 10480, 10480
.short 10464, 10720, 9960, 9960, 9960, 10216, 10472, 10472
.short 10456, 10712, 9952, 9952, 9952, 10208, 10464, 10464
.short 10608, 10864, 10104, 10104, 10104, 10360, 10616, 10616
.short 10600, 10856, 10096, 10096, 10096, 10352, 10608, 10608
.short 10592, 10848, 10088, 10088, 10088, 10344, 10600, 10600
.short 10584, 10840, 10080, 10080, 10080, 10336, 10592, 10592
.short 11184, 10936, 10936, 10936, 10936, 10936, 11192, 11192
.short 11176, 10928, 10928, 10928, 10928, 10928, 11184, 11184
.short 11168, 10920, 10920, 10920, 10920, 10920, 11176, 11176
.short 11160, 10912, 10912, 10912, 10912, 10912, 11168, 11168
.short 11312, 11064, 11064, 11064, 11064, 11064, 11320, 11320
.short 11304, 11056, 11056, 11056, 11056, 11056, 11312, 11312
.short 11296, 11048, 11048, 11048, 11048, 11048, 11304, 11304
.short 11288, 11040, 11040, 11040, 11040, 11040, 11296, 11296
.short 11248, 11000, 11000, 11000, 11000, 11000, 11256, 11256
.short 11240, 10992, 10992, 10992, 10992, 10992, 11248, 11248
.short 11232, 10984, 10984, 10984, 10984, 10984, 11240, 11240
.short 11224, 10976, 10976, 10976, 10976, 10976, 11232, 11232
.short 11376, 11128, 11128, 11128, 11128, 11128, 11384, 11384
.short 11368, 11120, 11120, 11120, 11120, 11120, 11376, 11376
.short 11360, 11112, 11112, 11112, 11112, 11112, 11368, 11368
.short 11352, 11104, 11104, 11104, 11104, 11104, 11360, 11360
.short 11696, 11448, 11448, 11448, 11448, 11448, 11704, 11704
.short 11688, 11440, 11440, 11440, 11440, 11440, 11696, 11696
.short 11680, 11432, 11432, 11432, 11432, 11432, 11688, 11688
.short 11672, 11424, 11424, 11424, 11424, 11424, 11680, 11680
.short 11824, 11576, 11576, 11576, 11576, 11576, 11832, 11832
.short 11816, 11568, 11568, 11568, 11568, 11568, 11824, 11824
.short 11808, 11560, 11560, 11560, 11560, 11560, 11816, 11816
.short 11800, 11552, 11552, 11552, 11552, 11552, 11808, 11808
.short 11760, 11512, 11512, 11512, 11512, 11512, 11768, 11768
.short 11752, 11504, 11504, 11504, 11504, 11504, 11760, 11760
.short 11744, 11496, 11496, 11496, 11496, 11496, 11752, 11752
.short 11736, 11488, 11488, 11488, 11488, 11488, 11744, 11744
.short 11888, 11640, 11640, 11640, 11640, 11640, 11896, 11896
.short 11880, 11632, 11632, 11632, 11632, 11632, 11888, 11888
.short 11872, 11624, 11624, 11624, 11624, 11624, 11880, 11880
.short 11864, 11616, 11616, 11616, 11616, 11616, 11872, 11872
.short 9144, 9400, 9656, 11960, 11960, 11968, 11968, 43904
.short 9136, 9392, 9648, 11952, 11952, 11952, 11960, 43920
.short 9128, 9384, 9640, 11944, 11944, 11952, 11952, 43936
.short 9120, 9376, 9632, 11936, 11936, 11936, 11944, 43952
.short 9272, 9528, 9784, 12088, 12088, 12096, 12096, 44480
.short 9264, 9520, 9776, 12080, 12080, 12080, 12088, 44496
.short 9256, 9512, 9768, 12072, 12072, 12080, 12080, 44512
.short 9248, 9504, 9760, 12064, 12064, 12064, 12072, 44528
.short 9208, 9464, 9720, 12024, 12024, 12032, 12032, 44192
.short 9200, 9456, 9712, 12016, 12016, 12016, 12024, 44208
.short 9192, 9448, 9704, 12008, 12008, 12016, 12016, 44224
.short 9184, 9440, 9696, 12000, 12000, 12000, 12008, 44240
.short 9336, 9592, 9848, 12152, 12152, 12160, 12160, 44768
.short 9328, 9584, 9840, 12144, 12144, 12144, 12152, 44784
.short 9320, 9576, 9832, 12136, 12136, 12144, 12144, 44800
.short 9312, 9568, 9824, 12128, 12128, 12128, 12136, 44816
.short 10424, 10680, 9920, 12216, 12216, 12224, 12224, 45056
.short 10416, 10672, 9912, 12208, 12208, 12208, 12216, 45072
.short 10408, 10664, 9904, 12200, 12200, 12208, 12208, 45088
.short 10400, 10656, 9896, 12192, 12192, 12192, 12200, 45104
.short 10552, 10808, 10048, 12344, 12344, 12352, 12352, 45632
.short 10544, 10800, 10040, 12336, 12336, 12336, 12344, 45648
.short 10536, 10792, 10032, 12328, 12328, 12336, 12336, 45664
.short 10528, 10784, 10024, 12320, 12320, 12320, 12328, 45680
.short 10488, 10744, 9984, 12280, 12280, 12288, 12288, 45344
.short 10480, 10736, 9976, 12272, 12272, 12272, 12280, 45360
.short 10472, 10728, 9968, 12264, 12264, 12272, 12272, 45376
.short 10464, 10720, 9960, 12256, 12256, 12256, 12264, 45392
.short 10616, 10872, 10880, 12408, 12408, 12416, 12416, 45920
.short 10608, 10864, 10104, 12400, 12400, 12400, 12408, 45936
.short 10600, 10856, 10096, 12392, 12392, 12400, 12400, 45952
.short 10592, 10848, 10088, 12384, 12384, 12384, 12392, 45968
.short 11192, 10944, 10944, 12472, 12472, 12480, 12480, 46208
.short 11184, 10936, 10936, 12464, 12464, 12464, 12472, 46224
.short 11176, 10928, 10928, 12456, 12456, 12464, 12464, 46240
.short 11168, 10920, 10920, 12448, 12448, 12448, 12456, 46256
.short 11320, 11072, 11072, 12600, 12600, 12608, 12608, 46784
.short 11312, 11064, 11064, 12592, 12592, 12592, 12600, 46800
.short 11304, 11056, 11056, 12584, 12584, 12592, 12592, 46816
.short 11296, 11048, 11048, 12576, 12576, 12576, 12584, 46832
.short 11256, 11008, 11008, 12536, 12536, 12544, 12544, 46496
.short 11248, 11000, 11000, 12528, 12528, 12528, 12536, 46512
.short 11240, 10992, 10992, 12520, 12520, 12528, 12528, 46528
.short 11232, 10984, 10984, 12512, 12512, 12512, 12520, 46544
.short 11384, 11392, 11392, 12664, 12664, 12672, 12672, 47072
.short 11376, 11128, 11128, 12656, 12656, 12656, 12664, 47088
.short 11368, 11120, 11120, 12648, 12648, 12656, 12656, 47104
.short 11360, 11112, 11112, 12640, 12640, 12640, 12648, 47120
.short 11704, 11456, 11456, 12728, 12728, 12736, 12736, 47360
.short 11696, 11448, 11448, 12720, 12720, 12720, 12728, 47376
.short 11688, 11440, 11440, 12712, 12712, 12720, 12720, 47392
.short 11680, 11432, 11432, 12704, 12704, 12704, 12712, 47408
.short 11832, 11584, 11584, 12856, 12856, 12864, 12864, 47936
.short 11824, 11576, 11576, 12848, 12848, 12848, 12856, 47952
.short 11816, 11568, 11568, 12840, 12840, 12848, 12848, 47968
.short 11808, 11560, 11560, 12832, 12832, 12832, 12840, 47984
.short 11768, 11520, 11520, 12792, 12792, 12800, 12800, 47648
.short 11760, 11512, 11512, 12784, 12784, 12784, 12792, 47664
.short 11752, 11504, 11504, 12776, 12776, 12784, 12784, 47680
.short 11744, 11496, 11496, 12768, 12768, 12768, 12776, 47696
.short 11896, 11904, 11904, 12920, 12920, 12928, 12928, 48224
.short 11888, 11640, 11640, 12912, 12912, 12912, 12920, 48240
.short 11880, 11632, 11632, 12904, 12904, 12912, 12912, 48256
.short 11872, 11624, 11624, 12896, 12896, 12896, 12904, 48272
.short 9104, 9360, 9616, 7832, 8088, 8344, 8600, 8856
.short 9096, 9352, 9608, 7824, 8080, 8336, 8592, 8848
.short 9088, 9344, 9600, 7816, 8072, 8328, 8584, 8840
.short 192, 192, 192, 7808, 8064, 8320, 8576, 8832
.short 9232, 9488, 9744, 7960, 8216, 8472, 8728, 8984
.short 9224, 9480, 9736, 7952, 8208, 8464, 8720, 8976
.short 9216, 9472, 9728, 7944, 8200, 8456, 8712, 8968
.short 9208, 9464, 9720, 7936, 8192, 8448, 8704, 8960
.short 9168, 9424, 9680, 7896, 8152, 8408, 8664, 8920
.short 9160, 9416, 9672, 7888, 8144, 8400, 8656, 8912
.short 9152, 9408, 9664, 7880, 8136, 8392, 8648, 8904
.short 9144, 9400, 9656, 7872, 8128, 8384, 8640, 8896
.short 9296, 9552, 9808, 8024, 8280, 8536, 8792, 9048
.short 9288, 9544, 9800, 8016, 8272, 8528, 8784, 9040
.short 9280, 9536, 9792, 8008, 8264, 8520, 8776, 9032
.short 9272, 9528, 9784, 8000, 8256, 8512, 8768, 9024
.short 10384, 10640, 9880, 9880, 9880, 10136, 10392, 10392
.short 10376, 10632, 9872, 9872, 9872, 10128, 10384, 10384
.short 10368, 10624, 9864, 9864, 9864, 10120, 10376, 10376
.short 9336, 9592, 9848, 9856, 9856, 10112, 10368, 10368
.short 10512, 10768, 10008, 10008, 10008, 10264, 10520, 10520
.short 10504, 10760, 10000, 10000, 10000, 10256, 10512, 10512
.short 10496, 10752, 9992, 9992, 9992, 10248, 10504, 10504
.short 10488, 10744, 9984, 9984, 9984, 10240, 10496, 10496
.short 10448, 10704, 9944, 9944, 9944, 10200, 10456, 10456
.short 10440, 10696, 9936, 9936, 9936, 10192, 10448, 10448
.short 10432, 10688, 9928, 9928, 9928, 10184, 10440, 10440
.short 10424, 10680, 9920, 9920, 9920, 10176, 10432, 10432
.short 10576, 10832, 10072, 10072, 10072, 10328, 10584, 10584
.short 10568, 10824, 10064, 10064, 10064, 10320, 10576, 10576
.short 10560, 10816, 10056, 10056, 10056, 10312, 10568, 10568
.short 10552, 10808, 10048, 10048, 10048, 10304, 10560, 10560
.short 11152, 10904, 10904, 10904, 10904, 10904, 11160, 11160
.short 11144, 10896, 10896, 10896, 10896, 10896, 11152, 11152
.short 11136, 10888, 10888, 10888, 10888, 10888, 11144, 11144
.short 10616, 10872, 10880, 10880, 10880, 10880, 11136, 11136
.short 11280, 11032, 11032, 11032, 11032, 11032, 11288, 11288
.short 11272, 11024, 11024, 11024, 11024, 11024, 11280, 11280
.short 11264, 11016, 11016, 11016, 11016, 11016, 11272, 11272
.short 11256, 11008, 11008, 11008, 11008, 11008, 11264, 11264
.short 11216, 10968, 10968, 10968, 10968, 10968, 11224, 11224
.short 11208, 10960, 10960, 10960, 10960, 10960, 11216, 11216
.short 11200, 10952, 10952, 10952, 10952, 10952, 11208, 11208
.short 11192, 10944, 10944, 10944, 10944, 10944, 11200, 11200
.short 11344, 11096, 11096, 11096, 11096, 11096, 11352, 11352
.short 11336, 11088, 11088, 11088, 11088, 11088, 11344, 11344
.short 11328, 11080, 11080, 11080, 11080, 11080, 11336, 11336
.short 11320, 11072, 11072, 11072, 11072, 11072, 11328, 11328
.short 11664, 11416, 11416, 11416, 11416, 11416, 11672, 11672
.short 11656, 11408, 11408, 11408, 11408, 11408, 11664, 11664
.short 11648, 11400, 11400, 11400, 11400, 11400, 11656, 11656
.short 11384, 11392, 11392, 11392, 11392, 11392, 11648, 11648
.short 11792, 11544, 11544, 11544, 11544, 11544, 11800, 11800
.short 11784, 11536, 11536, 11536, 11536, 11536, 11792, 11792
.short 11776, 11528, 11528, 11528, 11528, 11528, 11784, 11784
.short 11768, 11520, 11520, 11520, 11520, 11520, 11776, 11776
.short 11728, 11480, 11480, 11480, 11480, 11480, 11736, 11736
.short 11720, 11472, 11472, 11472, 11472, 11472, 11728, 11728
.short 11712, 11464, 11464, 11464, 11464, 11464, 11720, 11720
.short 11704, 11456, 11456, 11456, 11456, 11456, 11712, 11712
.short 11856, 11608, 11608, 11608, 11608, 11608, 11864, 11864
.short 11848, 11600, 11600, 11600, 11600, 11600, 11856, 11856
.short 11840, 11592, 11592, 11592, 11592, 11592, 11848, 11848
.short 11832, 11584, 11584, 11584, 11584, 11584, 11840, 11840
.short 9112, 9368, 9624, 11928, 11928, 11936, 11936, 58320
.short 9104, 9360, 9616, 11920, 11920, 11920, 11928, 58336
.short 9096, 9352, 9608, 11912, 11912, 11920, 11920, 58352
.short 9088, 9344, 9600, 11896, 11904, 11904, 11912, 58368
.short 9240, 9496, 9752, 12056, 12056, 12064, 12064, 58896
.short 9232, 9488, 9744, 12048, 12048, 12048, 12056, 58912
.short 9224, 9480, 9736, 12040, 12040, 12048, 12048, 58928
.short 9216, 9472, 9728, 12032, 12032, 12032, 12040, 58944
.short 9176, 9432, 9688, 11992, 11992, 12000, 12000, 58608
.short 9168, 9424, 9680, 11984, 11984, 11984, 11992, 58624
.short 9160, 9416, 9672, 11976, 11976, 11984, 11984, 58640
.short 9152, 9408, 9664, 11968, 11968, 11968, 11976, 58656
.short 9304, 9560, 9816, 12120, 12120, 12128, 12128, 59184
.short 9296, 9552, 9808, 12112, 12112, 12112, 12120, 59200
.short 9288, 9544, 9800, 12104, 12104, 12112, 12112, 59216
.short 9280, 9536, 9792, 12096, 12096, 12096, 12104, 59232
.short 10392, 10648, 9888, 12184, 12184, 12192, 12192, 59472
.short 10384, 10640, 9880, 12176, 12176, 12176, 12184, 59488
.short 10376, 10632, 9872, 12168, 12168, 12176, 12176, 59504
.short 10368, 10624, 9864, 12160, 12160, 12160, 12168, 59520
.short 10520, 10776, 10016, 12312, 12312, 12320, 12320, 60048
.short 10512, 10768, 10008, 12304, 12304, 12304, 12312, 60064
.short 10504, 10760, 10000, 12296, 12296, 12304, 12304, 60080
.short 10496, 10752, 9992, 12288, 12288, 12288, 12296, 60096
.short 10456, 10712, 9952, 12248, 12248, 12256, 12256, 59760
.short 10448, 10704, 9944, 12240, 12240, 12240, 12248, 59776
.short 10440, 10696, 9936, 12232, 12232, 12240, 12240, 59792
.short 10432, 10688, 9928, 12224, 12224, 12224, 12232, 59808
.short 10584, 10840, 10080, 12376, 12376, 12384, 12384, 60336
.short 10576, 10832, 10072, 12368, 12368, 12368, 12376, 60352
.short 10568, 10824, 10064, 12360, 12360, 12368, 12368, 60368
.short 10560, 10816, 10056, 12352, 12352, 12352, 12360, 60384
.short 11160, 10912, 10912, 12440, 12440, 12448, 12448, 60624
.short 11152, 10904, 10904, 12432, 12432, 12432, 12440, 60640
.short 11144, 10896, 10896, 12424, 12424, 12432, 12432, 60656
.short 11136, 10888, 10888, 12416, 12416, 12416, 12424, 60672
.short 11288, 11040, 11040, 12568, 12568, 12576, 12576, 61200
.short 11280, 11032, 11032, 12560, 12560, 12560, 12568, 61216
.short 11272, 11024, 11024, 12552, 12552, 12560, 12560, 61232
.short 11264, 11016, 11016, 12544, 12544, 12544, 12552, 61248
.short 11224, 10976, 10976, 12504, 12504, 12512, 12512, 60912
.short 11216, 10968, 10968, 12496, 12496, 12496, 12504, 60928
.short 11208, 10960, 10960, 12488, 12488, 12496, 12496, 60944
.short 11200, 10952, 10952, 12480, 12480, 12480, 12488, 60960
.short 11352, 11104, 11104, 12632, 12632, 12640, 12640, 61488
.short 11344, 11096, 11096, 12624, 12624, 12624, 12632, 61504
.short 11336, 11088, 11088, 12616, 12616, 12624, 12624, 61520
.short 11328, 11080, 11080, 12608, 12608, 12608, 12616, 61536
.short 11672, 11424, 11424, 12696, 12696, 12704, 12704, 61776
.short 11664, 11416, 11416, 12688, 12688, 12688, 12696, 61792
.short 11656, 11408, 11408, 12680, 12680, 12688, 12688, 61808
.short 11648, 11400, 11400, 12672, 12672, 12672, 12680, 61824
.short 11800, 11552, 11552, 12824, 12824, 12832, 12832, 62352
.short 11792, 11544, 11544, 12816, 12816, 12816, 12824, 62368
.short 11784, 11536, 11536, 12808, 12808, 12816, 12816, 62384
.short 11776, 11528, 11528, 12800, 12800, 12800, 12808, 62400
.short 11736, 11488, 11488, 12760, 12760, 12768, 12768, 62064
.short 11728, 11480, 11480, 12752, 12752, 12752, 12760, 62080
.short 11720, 11472, 11472, 12744, 12744, 12752, 12752, 62096
.short 11712, 11464, 11464, 12736, 12736, 12736, 12744, 62112
.short 11864, 11616, 11616, 12888, 12888, 12896, 12896, 62640
.short 11856, 11608, 11608, 12880, 12880, 12880, 12888, 62656
.short 11848, 11600, 11600, 12872, 12872, 12880, 12880, 62672
.short 11840, 11592, 11592, 12864, 12864, 12864, 12872, 62688
.size L_table, 8192
.section .rodata,"a"
.p2align 6
.amdhsa_kernel sequential_preLN__ssm_conv_s4__moe_arch_mod__prompt_kernel
  .amdhsa_next_free_vgpr 256
  .amdhsa_next_free_sgpr 96
  .amdhsa_accum_offset 256
  .amdhsa_group_segment_fixed_size 0
  .amdhsa_kernarg_size 136
  .amdhsa_user_sgpr_count 2
  .amdhsa_user_sgpr_kernarg_segment_ptr 1
  .amdhsa_system_sgpr_workgroup_id_x 1
  .amdhsa_float_denorm_mode_32 3
.end_amdhsa_kernel
```
